```python
import torch

def _softmax(x, axis=-1):
    return torch.softmax(x, dim=axis)

def _gelu(x):
    return torch.nn.functional.gelu(x, approximate='tanh')

def _silu(x):
    return torch.nn.functional.silu(x)

def _sigmoid(x):
    return torch.sigmoid(x)

def _layernorm(x, axis=-1, eps=1e-05):
    m = x.mean(dim=axis, keepdim=True)
    v = x.var(dim=axis, keepdim=True, unbiased=False)
    return (x - m) / torch.sqrt(v + eps)

def _scatter_add(tgt, idx, src, axis=0):
    return tgt.clone().index_add_(axis, idx, src)

def _segment_sum(src, seg, n):
    out = torch.zeros((n,) + src.shape[1:], dtype=src.dtype)
    return out.index_add_(0, seg, src)

def _pad(x, pw):
    flat = tuple((v for pair in reversed(pw) for v in pair))
    return torch.nn.functional.pad(x, flat)
kernel_name = 'standalone__video_videomae__vision'

def setup_inputs():

    _w = lambda a: (lambda t: t.to(torch.bfloat16) if t.is_floating_point() else t)(torch.as_tensor(a))
    T = 4
    N = 384
    C = max(384 // 4 * 4, 8)
    sc = C ** (-0.5)
    return {'x': _w((lambda *s: torch.randn(*s, dtype=torch.bfloat16) * 1.6)(1, T, N, C)), 'w_qkv_t': _w((lambda *s: torch.randn(*s, dtype=torch.bfloat16) * 1.6)(C, 3 * C) * sc), 'w_proj_t': _w((lambda *s: torch.randn(*s, dtype=torch.bfloat16) * 1.6)(C, C) * sc), 'w_qkv_s': _w((lambda *s: torch.randn(*s, dtype=torch.bfloat16) * 1.6)(C, 3 * C) * sc), 'w_proj_s': _w((lambda *s: torch.randn(*s, dtype=torch.bfloat16) * 3.2)(C, C) * sc), 'w1': _w((lambda *s: torch.randn(*s, dtype=torch.bfloat16) * 3.2)(C, 4 * C) * sc), 'w2': _w((lambda *s: torch.randn(*s, dtype=torch.bfloat16) * 0.8)(4 * C, C) * sc)}

def reference(x, w_qkv_t, w_proj_t, w_qkv_s, w_proj_s, w1, w2):
    B, T, N, C = x.shape
    Hd = 4
    D = C // Hd
    scale = D ** (-0.5)
    h = _layernorm(x, axis=-1)
    qkv = torch.einsum('btnc,ce->btne', h, w_qkv_t).reshape(B, T, N, 3, Hd, D)
    q = qkv[:, :, :, 0, :, :].clone()
    k = qkv[:, :, :, 1, :, :].clone()
    v = qkv[:, :, :, 2, :, :].clone()
    a = torch.einsum('btnhd,bsnhd->bnhts', q, k) * scale
    a = _softmax(a, axis=-1)
    o = torch.einsum('bnhts,bsnhd->btnhd', a, v).reshape(B, T, N, C)
    x = x + torch.einsum('btnc,ce->btne', o, w_proj_t)
    h = _layernorm(x, axis=-1)
    qkv = torch.einsum('btnc,ce->btne', h, w_qkv_s).reshape(B, T, N, 3, Hd, D)
    q = qkv[:, :, :, 0, :, :].clone()
    k = qkv[:, :, :, 1, :, :].clone()
    v = qkv[:, :, :, 2, :, :].clone()
    a = torch.einsum('btnhd,btmhd->bthnm', q, k) * scale
    a = _softmax(a, axis=-1)
    o = torch.einsum('bthnm,btmhd->btnhd', a, v).reshape(B, T, N, C)
    x = x + torch.einsum('btnc,ce->btne', o, w_proj_s)
    h = _layernorm(x, axis=-1)
    return x + _gelu(h @ w1) @ w2
```

```asm
; @launch kernel=km_kernel grid=(256,1,1) block=(256,1,1) lds=77888
.amdgcn_target "amdgcn-amd-amdhsa--gfx950"
.text
.globl km_kernel
.p2align 8
.type km_kernel,@function
km_kernel:
    s_cmp_ge_u32 s2, 256
    s_cbranch_scc1 kb_end
    s_load_dwordx16 s[84:99], s[0:1], 0
    s_load_dwordx4 s[4:7], s[0:1], 64
    v_mov_b32 v9, v0
    v_lshrrev_b32 v1, 6, v0
    v_and_b32 v0, 63, v0
    s_and_b32 s10, s2, 7
    v_readfirstlane_b32 s3, v1
    s_lshr_b32 s11, s2, 3
    s_lshl_b32 s12, s10, 2
    s_and_b32 s13, s11, 3
    s_add_u32 s12, s12, s13
    s_lshr_b32 s13, s11, 2
    v_lshlrev_b32 v1, 4, v0
    v_lshrrev_b32 v2, 4, v0
    v_and_b32 v3, 15, v0
    v_lshlrev_b32 v5, 2, v0
    s_mul_i32 s14, s12, 3
    s_mul_i32 s15, s13, 3
    s_add_u32 s19, s14, s3
    s_and_b32 s68, s13, 1
    s_and_b32 s69, s3, 1
    s_mov_b32 s62, s68
    s_add_u32 s63, s68, 1
    s_cmp_eq_u32 s68, 1
    s_cselect_b32 s64, 0, 2
    s_mov_b32 s65, s69
    s_add_u32 s66, s69, 1
    s_cmp_eq_u32 s69, 1
    s_cselect_b32 s67, 0, 2
    s_lshr_b32 s42, s13, 1
    s_mul_i32 s42, s42, 3
    s_mul_i32 s38, s19, 12
    s_add_u32 s38, s38, s42
    s_lshl_b32 s38, s38, 10
    s_lshl_b32 s42, s68, 9
    s_add_u32 s39, s38, s42
    s_add_u32 s39, s39, 1024
    s_lshl_b32 s42, s68, 11
    s_add_u32 s38, s38, s42
    s_lshl_b32 s70, s69, 11
    s_lshl_b32 s71, s69, 9
    s_add_u32 s71, s71, 1024
    s_mov_b32 s72, 0xffff
    s_mov_b32 s73, 0xffff
    v_lshrrev_b32 v23, 1, v2
    v_lshl_add_u32 v23, v23, 4, v3
    v_lshlrev_b32 v23, 4, v23
    v_mul_u32_u24 v4, 768, v3
    v_lshl_add_u32 v4, v2, 3, v4
    s_mul_i32 s41, s19, 12288
    s_lshl_b32 s42, s15, 5
    s_add_u32 s41, s41, s42
    s_lshl_b32 s42, s62, 5
    s_add_u32 s74, s41, s42
    s_lshl_b32 s42, s63, 5
    s_add_u32 s75, s41, s42
    s_lshl_b32 s42, s64, 5
    s_add_u32 s76, s41, s42
    s_mul_i32 s16, s14, 12288
    s_mul_i32 s17, s3, 3072
    s_add_u32 s16, s16, s17
    s_mul_i32 s18, s15, 12288
    s_add_u32 s18, s18, s17
    s_lshl_b32 s44, s13, 2
    s_add_u32 s44, s44, s3
    s_mul_i32 s44, s44, 36864
    s_mul_i32 s42, s62, 12288
    s_add_u32 s77, s18, s42
    s_mul_i32 s42, s65, 12288
    s_add_u32 s80, s44, s42
    s_mul_i32 s42, s63, 12288
    s_add_u32 s78, s18, s42
    s_mul_i32 s42, s66, 12288
    s_add_u32 s81, s44, s42
    s_mul_i32 s42, s64, 12288
    s_add_u32 s79, s18, s42
    s_mul_i32 s42, s67, 12288
    s_add_u32 s82, s44, s42
    s_lshl_b32 s45, s12, 7
    s_add_u32 s45, s45, 17031168
    s_mov_b32 s46, s13
    s_and_b32 s42, s46, 7
    s_lshr_b32 s46, s46, 3
    s_lshl_b32 s46, s46, 5
    s_add_u32 s46, s46, s42
    s_lshl_b32 s46, s46, 2
    s_add_u32 s46, s46, s45
    s_mov_b32 s40, 0x4000
    s_waitcnt lgkmcnt(0)
    s_mov_b32 s20, s6
    s_and_b32 s21, s7, 0xffff
    s_mov_b32 s22, 0x1090000
    s_mov_b32 s23, 0x20000
    s_mov_b32 s24, s84
    s_and_b32 s25, s85, 0xffff
    s_mov_b32 s26, 0x120000
    s_mov_b32 s27, 0x20000
    s_mov_b32 s28, s98
    s_and_b32 s29, s99, 0xffff
    s_mov_b32 s30, 0x120000
    s_mov_b32 s31, 0x20000
    s_mov_b32 s8, s4
    s_and_b32 s9, s5, 0xffff
    s_mov_b32 s10, 0x100
    s_mov_b32 s11, 0x20000
    s_and_b32 s55, s2, 1
    s_lshl_b32 s55, s55, 7
    v_mov_b32 v18, 77824
    v_mov_b32 v24, 0
    ds_write_b32 v18, v24
    s_sub_u32 s36, s2, 192
    s_cmp_ge_u32 s2, 192
    s_cbranch_scc1 p1_helper
    s_mov_b32 s56, s86
    s_and_b32 s57, s87, 0xffff
    s_mov_b32 s58, 0xd8000
    s_mov_b32 s59, 0x20000
    s_and_b32 s36, s2, 7
    s_lshr_b32 s37, s36, 1
    s_and_b32 s36, s36, 1
    s_lshr_b32 s35, s2, 3
    s_lshl_b32 s35, s35, 1
    s_add_u32 s35, s35, s36
    s_lshl_b32 s36, s35, 3
    v_lshrrev_b32 v6, 3, v0
    s_lshl_b32 s42, s3, 3
    v_add_u32 v6, s42, v6
    v_and_b32 v7, 3, v6
    v_mul_u32_u24 v7, 384, v7
    v_lshrrev_b32 v8, 2, v6
    v_add3_u32 v7, v7, v8, s36
    v_mul_u32_u24 v7, 768, v7
    v_and_b32 v8, 7, v0
    v_lshl_add_u32 v7, v8, 4, v7
    buffer_load_dwordx4 v[24:27], v7, s[24:27], 0 offen offset:0
    buffer_load_dwordx4 v[28:31], v7, s[24:27], 0 offen offset:128
    buffer_load_dwordx4 v[32:35], v7, s[24:27], 0 offen offset:256
    buffer_load_dwordx4 v[36:39], v7, s[24:27], 0 offen offset:384
    buffer_load_dwordx4 v[40:43], v7, s[24:27], 0 offen offset:512
    buffer_load_dwordx4 v[44:47], v7, s[24:27], 0 offen offset:640
    v_mul_u32_u24 v10, 18432, v2
    v_mul_u32_u24 v11, 12, v3
    v_add_u32 v10, v10, v11
    v_add_u32 v11, 4608, v10
    v_add_u32 v12, 9216, v10
    v_add_u32 v13, 13824, v10
    s_mul_i32 s47, s37, 192
    s_mul_i32 s48, s3, 768
    s_add_u32 s47, s47, s48
    s_lshr_b32 s33, s2, 3
    s_cmp_ge_u32 s33, 12
    s_cselect_b32 s34, 12, 0
    s_sub_u32 s33, s33, s34
    s_lshl_b32 s34, s33, 10
    s_mul_i32 s33, s33, 73728
    s_mov_b32 s60, 0x05040100
    s_mov_b32 s61, 0x07060302
    v_lshrrev_b32 v7, 4, v6
    v_mul_u32_u24 v7, 12288, v7
    v_lshrrev_b32 v14, 2, v8
    v_lshl_add_u32 v7, v14, 10, v7
    v_and_b32 v14, 3, v8
    v_lshl_add_u32 v7, v14, 8, v7
    v_and_b32 v14, 15, v6
    v_lshl_add_u32 v7, v14, 4, v7
    v_bfe_u32 v20, v0, 2, 2
    s_mov_b32 s49, 0x3e16c740
    v_and_b32 v21, 3, v0
    v_mul_u32_u24 v21, 0x48000, v21
    v_lshl_add_u32 v21, v2, 8, v21
    v_lshl_add_u32 v21, v20, 4, v21
    s_lshr_b32 s50, s36, 4
    s_mul_i32 s50, s50, 12
    s_mul_i32 s51, s37, 3
    s_add_u32 s50, s50, s51
    s_lshl_b32 s50, s50, 10
    s_and_b32 s51, s36, 15
    s_lshl_b32 s51, s51, 4
    s_add_u32 s50, s50, s51
    s_add_u32 s50, s50, 3858432
    s_mul_i32 s51, s35, 43
    s_lshr_b32 s51, s51, 8
    s_mul_i32 s52, s51, 6
    s_sub_u32 s52, s35, s52
    s_lshl_b32 s52, s52, 2
    s_add_u32 s52, s52, s37
    s_and_b32 s53, s52, 7
    s_lshr_b32 s52, s52, 3
    s_lshl_b32 s52, s52, 5
    s_add_u32 s52, s52, s53
    s_lshl_b32 s52, s52, 2
    s_lshl_b32 s51, s51, 9
    s_add_u32 s51, s51, s52
    s_add_u32 s51, s51, 17047552
    s_cmp_eq_u32 s3, 3
    s_cbranch_scc1 p1_w3
    s_add_u32 s48, s47, s33
    s_add_u32 s33, s33, 73728
    s_cmp_eq_u32 s33, 884736
    s_cselect_b32 s33, 0, s33
    buffer_load_dwordx3 v[96:98], v10, s[56:59], s48 offen offset:0
    buffer_load_dwordx3 v[100:102], v10, s[56:59], s48 offen offset:2304
    buffer_load_dwordx3 v[104:106], v11, s[56:59], s48 offen offset:0
    buffer_load_dwordx3 v[108:110], v11, s[56:59], s48 offen offset:2304
    buffer_load_dwordx3 v[112:114], v12, s[56:59], s48 offen offset:0
    buffer_load_dwordx3 v[116:118], v12, s[56:59], s48 offen offset:2304
    buffer_load_dwordx3 v[120:122], v13, s[56:59], s48 offen offset:0
    buffer_load_dwordx3 v[124:126], v13, s[56:59], s48 offen offset:2304
    s_add_u32 s48, s47, s33
    s_add_u32 s33, s33, 73728
    s_cmp_eq_u32 s33, 884736
    s_cselect_b32 s33, 0, s33
    buffer_load_dwordx3 v[128:130], v10, s[56:59], s48 offen offset:0
    buffer_load_dwordx3 v[132:134], v10, s[56:59], s48 offen offset:2304
    buffer_load_dwordx3 v[136:138], v11, s[56:59], s48 offen offset:0
    buffer_load_dwordx3 v[140:142], v11, s[56:59], s48 offen offset:2304
    buffer_load_dwordx3 v[144:146], v12, s[56:59], s48 offen offset:0
    buffer_load_dwordx3 v[148:150], v12, s[56:59], s48 offen offset:2304
    buffer_load_dwordx3 v[152:154], v13, s[56:59], s48 offen offset:0
    buffer_load_dwordx3 v[156:158], v13, s[56:59], s48 offen offset:2304
    s_add_u32 s48, s47, s33
    s_add_u32 s33, s33, 73728
    s_cmp_eq_u32 s33, 884736
    s_cselect_b32 s33, 0, s33
    buffer_load_dwordx3 v[160:162], v10, s[56:59], s48 offen offset:0
    buffer_load_dwordx3 v[164:166], v10, s[56:59], s48 offen offset:2304
    buffer_load_dwordx3 v[168:170], v11, s[56:59], s48 offen offset:0
    buffer_load_dwordx3 v[172:174], v11, s[56:59], s48 offen offset:2304
    buffer_load_dwordx3 v[176:178], v12, s[56:59], s48 offen offset:0
    buffer_load_dwordx3 v[180:182], v12, s[56:59], s48 offen offset:2304
    buffer_load_dwordx3 v[184:186], v13, s[56:59], s48 offen offset:0
    buffer_load_dwordx3 v[188:190], v13, s[56:59], s48 offen offset:2304
    s_add_u32 s48, s47, s33
    s_add_u32 s33, s33, 73728
    s_cmp_eq_u32 s33, 884736
    s_cselect_b32 s33, 0, s33
    buffer_load_dwordx3 v[192:194], v10, s[56:59], s48 offen offset:0
    buffer_load_dwordx3 v[196:198], v10, s[56:59], s48 offen offset:2304
    buffer_load_dwordx3 v[200:202], v11, s[56:59], s48 offen offset:0
    buffer_load_dwordx3 v[204:206], v11, s[56:59], s48 offen offset:2304
    buffer_load_dwordx3 v[208:210], v12, s[56:59], s48 offen offset:0
    buffer_load_dwordx3 v[212:214], v12, s[56:59], s48 offen offset:2304
    buffer_load_dwordx3 v[216:218], v13, s[56:59], s48 offen offset:0
    buffer_load_dwordx3 v[220:222], v13, s[56:59], s48 offen offset:2304
    s_waitcnt vmcnt(32)
    v_lshlrev_b32 v48, 16, v24
    v_and_b32 v49, 0xffff0000, v24
    v_lshlrev_b32 v50, 16, v25
    v_and_b32 v51, 0xffff0000, v25
    v_lshlrev_b32 v52, 16, v26
    v_and_b32 v53, 0xffff0000, v26
    v_lshlrev_b32 v54, 16, v27
    v_and_b32 v55, 0xffff0000, v27
    v_lshlrev_b32 v56, 16, v28
    v_and_b32 v57, 0xffff0000, v28
    v_lshlrev_b32 v58, 16, v29
    v_and_b32 v59, 0xffff0000, v29
    v_lshlrev_b32 v60, 16, v30
    v_and_b32 v61, 0xffff0000, v30
    v_lshlrev_b32 v62, 16, v31
    v_and_b32 v63, 0xffff0000, v31
    v_lshlrev_b32 v64, 16, v32
    v_and_b32 v65, 0xffff0000, v32
    v_lshlrev_b32 v66, 16, v33
    v_and_b32 v67, 0xffff0000, v33
pad0:
    s_cbranch_execz wretA
    v_lshlrev_b32 v68, 16, v34
    v_and_b32 v69, 0xffff0000, v34
    v_lshlrev_b32 v70, 16, v35
    v_and_b32 v71, 0xffff0000, v35
    v_lshlrev_b32 v72, 16, v36
    v_and_b32 v73, 0xffff0000, v36
    v_lshlrev_b32 v74, 16, v37
    v_and_b32 v75, 0xffff0000, v37
    s_add_u32 s48, s47, s33
    s_add_u32 s33, s33, 73728
    s_cmp_eq_u32 s33, 884736
    s_cselect_b32 s33, 0, s33
    buffer_load_dwordx3 v[224:226], v10, s[56:59], s48 offen offset:0
    v_lshlrev_b32 v76, 16, v38
    v_and_b32 v77, 0xffff0000, v38
    v_lshlrev_b32 v78, 16, v39
    v_and_b32 v79, 0xffff0000, v39
    v_lshlrev_b32 v80, 16, v40
    v_and_b32 v81, 0xffff0000, v40
    v_lshlrev_b32 v82, 16, v41
    v_and_b32 v83, 0xffff0000, v41
    v_lshlrev_b32 v84, 16, v42
    v_and_b32 v85, 0xffff0000, v42
    v_lshlrev_b32 v86, 16, v43
    v_and_b32 v87, 0xffff0000, v43
    v_lshlrev_b32 v88, 16, v44
    v_and_b32 v89, 0xffff0000, v44
    v_lshlrev_b32 v90, 16, v45
    v_and_b32 v91, 0xffff0000, v45
    v_lshlrev_b32 v92, 16, v46
    v_and_b32 v93, 0xffff0000, v46
    v_lshlrev_b32 v94, 16, v47
    v_and_b32 v95, 0xffff0000, v47
    v_pk_add_f32 v[14:15], v[48:49], v[50:51]
    v_pk_add_f32 v[16:17], v[52:53], v[54:55]
    v_pk_add_f32 v[14:15], v[14:15], v[56:57]
    v_pk_add_f32 v[16:17], v[16:17], v[58:59]
    v_pk_add_f32 v[14:15], v[14:15], v[60:61]
    buffer_load_dwordx3 v[228:230], v10, s[56:59], s48 offen offset:2304
    v_pk_add_f32 v[16:17], v[16:17], v[62:63]
    v_pk_add_f32 v[14:15], v[14:15], v[64:65]
    v_pk_add_f32 v[16:17], v[16:17], v[66:67]
    v_pk_add_f32 v[14:15], v[14:15], v[68:69]
    v_pk_add_f32 v[16:17], v[16:17], v[70:71]
    v_pk_add_f32 v[14:15], v[14:15], v[72:73]
    v_pk_add_f32 v[16:17], v[16:17], v[74:75]
    v_pk_add_f32 v[14:15], v[14:15], v[76:77]
    v_pk_add_f32 v[16:17], v[16:17], v[78:79]
    v_pk_add_f32 v[14:15], v[14:15], v[80:81]
    v_pk_add_f32 v[16:17], v[16:17], v[82:83]
    v_pk_add_f32 v[14:15], v[14:15], v[84:85]
    v_pk_add_f32 v[16:17], v[16:17], v[86:87]
    v_pk_add_f32 v[14:15], v[14:15], v[88:89]
    buffer_load_dwordx3 v[232:234], v11, s[56:59], s48 offen offset:0
    v_pk_add_f32 v[16:17], v[16:17], v[90:91]
    v_pk_add_f32 v[14:15], v[14:15], v[92:93]
    v_pk_add_f32 v[16:17], v[16:17], v[94:95]
    v_pk_add_f32 v[14:15], v[14:15], v[16:17]
    v_add_f32 v14, v14, v15
    s_nop 1
    v_add_f32_dpp v14, v14, v14 quad_perm:[1,0,3,2] row_mask:0xf bank_mask:0xf
    s_nop 1
    v_add_f32_dpp v14, v14, v14 quad_perm:[2,3,0,1] row_mask:0xf bank_mask:0xf
    s_nop 1
    v_add_f32_dpp v14, v14, v14 row_half_mirror row_mask:0xf bank_mask:0xf
    v_mul_f32 v14, 0xbb2aaaab, v14
    v_mov_b32 v15, v14
    v_pk_add_f32 v[48:49], v[48:49], v[14:15]
    v_pk_add_f32 v[50:51], v[50:51], v[14:15]
    v_pk_add_f32 v[52:53], v[52:53], v[14:15]
    v_pk_add_f32 v[54:55], v[54:55], v[14:15]
    v_pk_add_f32 v[56:57], v[56:57], v[14:15]
    v_pk_add_f32 v[58:59], v[58:59], v[14:15]
pad1:
    s_cbranch_execz wretA
    buffer_load_dwordx3 v[236:238], v11, s[56:59], s48 offen offset:2304
    v_pk_add_f32 v[60:61], v[60:61], v[14:15]
    v_pk_add_f32 v[62:63], v[62:63], v[14:15]
    v_pk_add_f32 v[64:65], v[64:65], v[14:15]
    v_pk_add_f32 v[66:67], v[66:67], v[14:15]
    v_pk_add_f32 v[68:69], v[68:69], v[14:15]
    v_pk_add_f32 v[70:71], v[70:71], v[14:15]
    v_pk_add_f32 v[72:73], v[72:73], v[14:15]
    v_pk_add_f32 v[74:75], v[74:75], v[14:15]
    v_pk_add_f32 v[76:77], v[76:77], v[14:15]
    v_pk_add_f32 v[78:79], v[78:79], v[14:15]
    v_pk_add_f32 v[80:81], v[80:81], v[14:15]
    v_pk_add_f32 v[82:83], v[82:83], v[14:15]
    v_pk_add_f32 v[84:85], v[84:85], v[14:15]
    v_pk_add_f32 v[86:87], v[86:87], v[14:15]
    buffer_load_dwordx3 v[240:242], v12, s[56:59], s48 offen offset:0
    v_pk_add_f32 v[88:89], v[88:89], v[14:15]
    v_pk_add_f32 v[90:91], v[90:91], v[14:15]
    v_pk_add_f32 v[92:93], v[92:93], v[14:15]
    v_pk_add_f32 v[94:95], v[94:95], v[14:15]
    v_pk_mul_f32 v[14:15], v[48:49], v[48:49]
    v_pk_mul_f32 v[16:17], v[50:51], v[50:51]
    v_pk_fma_f32 v[14:15], v[52:53], v[52:53], v[14:15]
    v_pk_fma_f32 v[16:17], v[54:55], v[54:55], v[16:17]
    v_pk_fma_f32 v[14:15], v[56:57], v[56:57], v[14:15]
    v_pk_fma_f32 v[16:17], v[58:59], v[58:59], v[16:17]
    v_pk_fma_f32 v[14:15], v[60:61], v[60:61], v[14:15]
    v_pk_fma_f32 v[16:17], v[62:63], v[62:63], v[16:17]
    v_pk_fma_f32 v[14:15], v[64:65], v[64:65], v[14:15]
    v_pk_fma_f32 v[16:17], v[66:67], v[66:67], v[16:17]
    v_pk_fma_f32 v[14:15], v[68:69], v[68:69], v[14:15]
    buffer_load_dwordx3 v[244:246], v12, s[56:59], s48 offen offset:2304
    v_pk_fma_f32 v[16:17], v[70:71], v[70:71], v[16:17]
    v_pk_fma_f32 v[14:15], v[72:73], v[72:73], v[14:15]
    v_pk_fma_f32 v[16:17], v[74:75], v[74:75], v[16:17]
    v_pk_fma_f32 v[14:15], v[76:77], v[76:77], v[14:15]
    v_pk_fma_f32 v[16:17], v[78:79], v[78:79], v[16:17]
    v_pk_fma_f32 v[14:15], v[80:81], v[80:81], v[14:15]
    v_pk_fma_f32 v[16:17], v[82:83], v[82:83], v[16:17]
    v_pk_fma_f32 v[14:15], v[84:85], v[84:85], v[14:15]
    v_pk_fma_f32 v[16:17], v[86:87], v[86:87], v[16:17]
    v_pk_fma_f32 v[14:15], v[88:89], v[88:89], v[14:15]
    v_pk_fma_f32 v[16:17], v[90:91], v[90:91], v[16:17]
    v_pk_fma_f32 v[14:15], v[92:93], v[92:93], v[14:15]
    v_pk_fma_f32 v[16:17], v[94:95], v[94:95], v[16:17]
    v_pk_add_f32 v[14:15], v[14:15], v[16:17]
    v_add_f32 v14, v14, v15
    buffer_load_dwordx3 v[248:250], v13, s[56:59], s48 offen offset:0
    s_nop 1
    v_add_f32_dpp v14, v14, v14 quad_perm:[1,0,3,2] row_mask:0xf bank_mask:0xf
    s_nop 1
    v_add_f32_dpp v14, v14, v14 quad_perm:[2,3,0,1] row_mask:0xf bank_mask:0xf
    s_nop 1
    v_add_f32_dpp v14, v14, v14 row_half_mirror row_mask:0xf bank_mask:0xf
    v_mov_b32 v15, 0x3727c5ac
    v_fmac_f32 v15, 0x3b2aaaab, v14
    v_rsq_f32 v14, v15
    s_nop 0
    v_mov_b32 v15, v14
    v_pk_mul_f32 v[48:49], v[48:49], v[14:15]
    v_cvt_pk_bf16_f32 v24, v48, v49
    v_pk_mul_f32 v[50:51], v[50:51], v[14:15]
    v_cvt_pk_bf16_f32 v25, v50, v51
    v_pk_mul_f32 v[52:53], v[52:53], v[14:15]
    v_cvt_pk_bf16_f32 v26, v52, v53
    v_pk_mul_f32 v[54:55], v[54:55], v[14:15]
    v_cvt_pk_bf16_f32 v27, v54, v55
pad2:
    s_cbranch_execz wretA
    ds_write_b128 v7, v[24:27] offset:0
    v_pk_mul_f32 v[56:57], v[56:57], v[14:15]
    v_cvt_pk_bf16_f32 v28, v56, v57
    v_pk_mul_f32 v[58:59], v[58:59], v[14:15]
    v_cvt_pk_bf16_f32 v29, v58, v59
    v_pk_mul_f32 v[60:61], v[60:61], v[14:15]
    v_cvt_pk_bf16_f32 v30, v60, v61
    v_pk_mul_f32 v[62:63], v[62:63], v[14:15]
    v_cvt_pk_bf16_f32 v31, v62, v63
    ds_write_b128 v7, v[28:31] offset:2048
    buffer_load_dwordx3 v[252:254], v13, s[56:59], s48 offen offset:2304
    v_pk_mul_f32 v[64:65], v[64:65], v[14:15]
    v_cvt_pk_bf16_f32 v32, v64, v65
    v_pk_mul_f32 v[66:67], v[66:67], v[14:15]
    v_cvt_pk_bf16_f32 v33, v66, v67
    v_pk_mul_f32 v[68:69], v[68:69], v[14:15]
    v_cvt_pk_bf16_f32 v34, v68, v69
    v_pk_mul_f32 v[70:71], v[70:71], v[14:15]
    v_cvt_pk_bf16_f32 v35, v70, v71
    ds_write_b128 v7, v[32:35] offset:4096
    v_pk_mul_f32 v[72:73], v[72:73], v[14:15]
    v_cvt_pk_bf16_f32 v36, v72, v73
    v_pk_mul_f32 v[74:75], v[74:75], v[14:15]
    v_cvt_pk_bf16_f32 v37, v74, v75
    v_pk_mul_f32 v[76:77], v[76:77], v[14:15]
    v_cvt_pk_bf16_f32 v38, v76, v77
    v_pk_mul_f32 v[78:79], v[78:79], v[14:15]
    v_cvt_pk_bf16_f32 v39, v78, v79
    ds_write_b128 v7, v[36:39] offset:6144
    v_pk_mul_f32 v[80:81], v[80:81], v[14:15]
    v_cvt_pk_bf16_f32 v40, v80, v81
    v_pk_mul_f32 v[82:83], v[82:83], v[14:15]
    v_cvt_pk_bf16_f32 v41, v82, v83
    v_pk_mul_f32 v[84:85], v[84:85], v[14:15]
    v_cvt_pk_bf16_f32 v42, v84, v85
    v_pk_mul_f32 v[86:87], v[86:87], v[14:15]
    v_cvt_pk_bf16_f32 v43, v86, v87
    ds_write_b128 v7, v[40:43] offset:8192
    v_pk_mul_f32 v[88:89], v[88:89], v[14:15]
    v_cvt_pk_bf16_f32 v44, v88, v89
    v_pk_mul_f32 v[90:91], v[90:91], v[14:15]
    v_cvt_pk_bf16_f32 v45, v90, v91
    v_pk_mul_f32 v[92:93], v[92:93], v[14:15]
    v_cvt_pk_bf16_f32 v46, v92, v93
    v_pk_mul_f32 v[94:95], v[94:95], v[14:15]
    v_cvt_pk_bf16_f32 v47, v94, v95
    ds_write_b128 v7, v[44:47] offset:10240
    s_waitcnt lgkmcnt(0)
    s_barrier
    s_cmp_eq_u32 s3, 2
    s_cbranch_scc1 p1_v
    v_add_u32 v6, s34, v1
    s_add_u32 s34, s34, 1024
    s_cmp_eq_u32 s34, 12288
    s_cselect_b32 s34, 0, s34
    ds_read_b128 v[72:75], v6 offset:0
    ds_read_b128 v[76:79], v6 offset:12288
    s_waitcnt vmcnt(32)
    v_perm_b32 v24, v100, v96, s60
    v_perm_b32 v25, v108, v104, s60
    v_perm_b32 v26, v116, v112, s60
    v_perm_b32 v27, v124, v120, s60
    v_perm_b32 v28, v100, v96, s61
    v_perm_b32 v29, v108, v104, s61
    v_perm_b32 v30, v116, v112, s61
    v_perm_b32 v31, v124, v120, s61
pad3:
    s_cbranch_execz wretA
    v_perm_b32 v32, v101, v97, s60
    v_perm_b32 v33, v109, v105, s60
    v_perm_b32 v34, v117, v113, s60
    v_perm_b32 v35, v125, v121, s60
    v_perm_b32 v36, v101, v97, s61
    v_perm_b32 v37, v109, v105, s61
    v_perm_b32 v38, v117, v113, s61
    v_perm_b32 v39, v125, v121, s61
    v_perm_b32 v40, v102, v98, s60
    v_perm_b32 v41, v110, v106, s60
    v_perm_b32 v42, v118, v114, s60
    v_perm_b32 v43, v126, v122, s60
    v_perm_b32 v44, v102, v98, s61
    v_perm_b32 v45, v110, v106, s61
    v_perm_b32 v46, v118, v114, s61
    v_perm_b32 v47, v126, v122, s61
    v_add_u32 v6, s34, v1
    s_add_u32 s34, s34, 1024
    s_cmp_eq_u32 s34, 12288
    s_cselect_b32 s34, 0, s34
    ds_read_b128 v[80:83], v6 offset:0
    ds_read_b128 v[84:87], v6 offset:12288
    s_add_u32 s48, s47, s33
    s_add_u32 s33, s33, 73728
    s_cmp_eq_u32 s33, 884736
    s_cselect_b32 s33, 0, s33
    buffer_load_dwordx3 v[96:98], v10, s[56:59], s48 offen offset:0
    buffer_load_dwordx3 v[100:102], v10, s[56:59], s48 offen offset:2304
    buffer_load_dwordx3 v[104:106], v11, s[56:59], s48 offen offset:0
    buffer_load_dwordx3 v[108:110], v11, s[56:59], s48 offen offset:2304
    buffer_load_dwordx3 v[112:114], v12, s[56:59], s48 offen offset:0
    buffer_load_dwordx3 v[116:118], v12, s[56:59], s48 offen offset:2304
    buffer_load_dwordx3 v[120:122], v13, s[56:59], s48 offen offset:0
    buffer_load_dwordx3 v[124:126], v13, s[56:59], s48 offen offset:2304
    s_waitcnt vmcnt(32) lgkmcnt(2)
    v_mfma_f32_16x16x32_bf16 a[144:147], v[24:27], v[72:75], 0
    v_mfma_f32_16x16x32_bf16 a[168:171], v[24:27], v[76:79], 0
    v_perm_b32 v48, v132, v128, s60
    v_perm_b32 v49, v140, v136, s60
    v_perm_b32 v50, v148, v144, s60
    v_perm_b32 v51, v156, v152, s60
    v_mfma_f32_16x16x32_bf16 a[148:151], v[28:31], v[72:75], 0
    v_mfma_f32_16x16x32_bf16 a[172:175], v[28:31], v[76:79], 0
    v_perm_b32 v52, v132, v128, s61
    v_perm_b32 v53, v140, v136, s61
    v_perm_b32 v54, v148, v144, s61
    v_perm_b32 v55, v156, v152, s61
    v_mfma_f32_16x16x32_bf16 a[152:155], v[32:35], v[72:75], 0
    v_mfma_f32_16x16x32_bf16 a[176:179], v[32:35], v[76:79], 0
    v_perm_b32 v56, v133, v129, s60
    v_perm_b32 v57, v141, v137, s60
    v_perm_b32 v58, v149, v145, s60
    v_perm_b32 v59, v157, v153, s60
    v_mfma_f32_16x16x32_bf16 a[156:159], v[36:39], v[72:75], 0
    v_mfma_f32_16x16x32_bf16 a[180:183], v[36:39], v[76:79], 0
    v_perm_b32 v60, v133, v129, s61
    v_perm_b32 v61, v141, v137, s61
    v_perm_b32 v62, v149, v145, s61
    v_perm_b32 v63, v157, v153, s61
    v_mfma_f32_16x16x32_bf16 a[160:163], v[40:43], v[72:75], 0
    v_mfma_f32_16x16x32_bf16 a[184:187], v[40:43], v[76:79], 0
    v_perm_b32 v64, v134, v130, s60
    v_perm_b32 v65, v142, v138, s60
    v_perm_b32 v66, v150, v146, s60
    v_perm_b32 v67, v158, v154, s60
pad4:
    s_cbranch_execz wretA
    v_mfma_f32_16x16x32_bf16 a[164:167], v[44:47], v[72:75], 0
    v_mfma_f32_16x16x32_bf16 a[188:191], v[44:47], v[76:79], 0
    v_perm_b32 v68, v134, v130, s61
    v_perm_b32 v69, v142, v138, s61
    v_perm_b32 v70, v150, v146, s61
    v_perm_b32 v71, v158, v154, s61
    v_add_u32 v6, s34, v1
    s_add_u32 s34, s34, 1024
    s_cmp_eq_u32 s34, 12288
    s_cselect_b32 s34, 0, s34
    ds_read_b128 v[72:75], v6 offset:0
    ds_read_b128 v[76:79], v6 offset:12288
    s_add_u32 s48, s47, s33
    s_add_u32 s33, s33, 73728
    s_cmp_eq_u32 s33, 884736
    s_cselect_b32 s33, 0, s33
    buffer_load_dwordx3 v[128:130], v10, s[56:59], s48 offen offset:0
    buffer_load_dwordx3 v[132:134], v10, s[56:59], s48 offen offset:2304
    buffer_load_dwordx3 v[136:138], v11, s[56:59], s48 offen offset:0
    buffer_load_dwordx3 v[140:142], v11, s[56:59], s48 offen offset:2304
    buffer_load_dwordx3 v[144:146], v12, s[56:59], s48 offen offset:0
    buffer_load_dwordx3 v[148:150], v12, s[56:59], s48 offen offset:2304
    buffer_load_dwordx3 v[152:154], v13, s[56:59], s48 offen offset:0
    buffer_load_dwordx3 v[156:158], v13, s[56:59], s48 offen offset:2304
    s_waitcnt vmcnt(32) lgkmcnt(2)
    v_mfma_f32_16x16x32_bf16 a[144:147], v[48:51], v[80:83], a[144:147]
    v_mfma_f32_16x16x32_bf16 a[168:171], v[48:51], v[84:87], a[168:171]
    v_perm_b32 v24, v164, v160, s60
    v_perm_b32 v25, v172, v168, s60
    v_perm_b32 v26, v180, v176, s60
    v_perm_b32 v27, v188, v184, s60
    v_mfma_f32_16x16x32_bf16 a[148:151], v[52:55], v[80:83], a[148:151]
    v_mfma_f32_16x16x32_bf16 a[172:175], v[52:55], v[84:87], a[172:175]
    v_perm_b32 v28, v164, v160, s61
    v_perm_b32 v29, v172, v168, s61
    v_perm_b32 v30, v180, v176, s61
    v_perm_b32 v31, v188, v184, s61
    v_mfma_f32_16x16x32_bf16 a[152:155], v[56:59], v[80:83], a[152:155]
    v_mfma_f32_16x16x32_bf16 a[176:179], v[56:59], v[84:87], a[176:179]
    v_perm_b32 v32, v165, v161, s60
    v_perm_b32 v33, v173, v169, s60
    v_perm_b32 v34, v181, v177, s60
    v_perm_b32 v35, v189, v185, s60
    v_mfma_f32_16x16x32_bf16 a[156:159], v[60:63], v[80:83], a[156:159]
    v_mfma_f32_16x16x32_bf16 a[180:183], v[60:63], v[84:87], a[180:183]
    v_perm_b32 v36, v165, v161, s61
    v_perm_b32 v37, v173, v169, s61
    v_perm_b32 v38, v181, v177, s61
    v_perm_b32 v39, v189, v185, s61
    v_mfma_f32_16x16x32_bf16 a[160:163], v[64:67], v[80:83], a[160:163]
    v_mfma_f32_16x16x32_bf16 a[184:187], v[64:67], v[84:87], a[184:187]
    v_perm_b32 v40, v166, v162, s60
    v_perm_b32 v41, v174, v170, s60
    v_perm_b32 v42, v182, v178, s60
    v_perm_b32 v43, v190, v186, s60
    v_mfma_f32_16x16x32_bf16 a[164:167], v[68:71], v[80:83], a[164:167]
    v_mfma_f32_16x16x32_bf16 a[188:191], v[68:71], v[84:87], a[188:191]
    v_perm_b32 v44, v166, v162, s61
    v_perm_b32 v45, v174, v170, s61
    v_perm_b32 v46, v182, v178, s61
    v_perm_b32 v47, v190, v186, s61
    v_add_u32 v6, s34, v1
    s_add_u32 s34, s34, 1024
    s_cmp_eq_u32 s34, 12288
    s_cselect_b32 s34, 0, s34
pad5:
    s_cbranch_execz wretA
    ds_read_b128 v[80:83], v6 offset:0
    ds_read_b128 v[84:87], v6 offset:12288
    s_add_u32 s48, s47, s33
    s_add_u32 s33, s33, 73728
    s_cmp_eq_u32 s33, 884736
    s_cselect_b32 s33, 0, s33
    buffer_load_dwordx3 v[160:162], v10, s[56:59], s48 offen offset:0
    buffer_load_dwordx3 v[164:166], v10, s[56:59], s48 offen offset:2304
    buffer_load_dwordx3 v[168:170], v11, s[56:59], s48 offen offset:0
    buffer_load_dwordx3 v[172:174], v11, s[56:59], s48 offen offset:2304
    buffer_load_dwordx3 v[176:178], v12, s[56:59], s48 offen offset:0
    buffer_load_dwordx3 v[180:182], v12, s[56:59], s48 offen offset:2304
    buffer_load_dwordx3 v[184:186], v13, s[56:59], s48 offen offset:0
    buffer_load_dwordx3 v[188:190], v13, s[56:59], s48 offen offset:2304
    s_waitcnt vmcnt(32) lgkmcnt(2)
    v_mfma_f32_16x16x32_bf16 a[144:147], v[24:27], v[72:75], a[144:147]
    v_mfma_f32_16x16x32_bf16 a[168:171], v[24:27], v[76:79], a[168:171]
    v_perm_b32 v48, v196, v192, s60
    v_perm_b32 v49, v204, v200, s60
    v_perm_b32 v50, v212, v208, s60
    v_perm_b32 v51, v220, v216, s60
    v_mfma_f32_16x16x32_bf16 a[148:151], v[28:31], v[72:75], a[148:151]
    v_mfma_f32_16x16x32_bf16 a[172:175], v[28:31], v[76:79], a[172:175]
    v_perm_b32 v52, v196, v192, s61
    v_perm_b32 v53, v204, v200, s61
    v_perm_b32 v54, v212, v208, s61
    v_perm_b32 v55, v220, v216, s61
    v_mfma_f32_16x16x32_bf16 a[152:155], v[32:35], v[72:75], a[152:155]
    v_mfma_f32_16x16x32_bf16 a[176:179], v[32:35], v[76:79], a[176:179]
    v_perm_b32 v56, v197, v193, s60
    v_perm_b32 v57, v205, v201, s60
    v_perm_b32 v58, v213, v209, s60
    v_perm_b32 v59, v221, v217, s60
    v_mfma_f32_16x16x32_bf16 a[156:159], v[36:39], v[72:75], a[156:159]
    v_mfma_f32_16x16x32_bf16 a[180:183], v[36:39], v[76:79], a[180:183]
    v_perm_b32 v60, v197, v193, s61
    v_perm_b32 v61, v205, v201, s61
    v_perm_b32 v62, v213, v209, s61
    v_perm_b32 v63, v221, v217, s61
    v_mfma_f32_16x16x32_bf16 a[160:163], v[40:43], v[72:75], a[160:163]
    v_mfma_f32_16x16x32_bf16 a[184:187], v[40:43], v[76:79], a[184:187]
    v_perm_b32 v64, v198, v194, s60
    v_perm_b32 v65, v206, v202, s60
    v_perm_b32 v66, v214, v210, s60
    v_perm_b32 v67, v222, v218, s60
    v_mfma_f32_16x16x32_bf16 a[164:167], v[44:47], v[72:75], a[164:167]
    v_mfma_f32_16x16x32_bf16 a[188:191], v[44:47], v[76:79], a[188:191]
    v_perm_b32 v68, v198, v194, s61
    v_perm_b32 v69, v206, v202, s61
    v_perm_b32 v70, v214, v210, s61
    v_perm_b32 v71, v222, v218, s61
    v_add_u32 v6, s34, v1
    s_add_u32 s34, s34, 1024
    s_cmp_eq_u32 s34, 12288
    s_cselect_b32 s34, 0, s34
    ds_read_b128 v[72:75], v6 offset:0
    ds_read_b128 v[76:79], v6 offset:12288
    s_add_u32 s48, s47, s33
    s_add_u32 s33, s33, 73728
    s_cmp_eq_u32 s33, 884736
    s_cselect_b32 s33, 0, s33
    buffer_load_dwordx3 v[192:194], v10, s[56:59], s48 offen offset:0
    buffer_load_dwordx3 v[196:198], v10, s[56:59], s48 offen offset:2304
    buffer_load_dwordx3 v[200:202], v11, s[56:59], s48 offen offset:0
    buffer_load_dwordx3 v[204:206], v11, s[56:59], s48 offen offset:2304
pad6:
    s_cbranch_execz wretA
    buffer_load_dwordx3 v[208:210], v12, s[56:59], s48 offen offset:0
    buffer_load_dwordx3 v[212:214], v12, s[56:59], s48 offen offset:2304
    buffer_load_dwordx3 v[216:218], v13, s[56:59], s48 offen offset:0
    buffer_load_dwordx3 v[220:222], v13, s[56:59], s48 offen offset:2304
    s_waitcnt vmcnt(32) lgkmcnt(2)
    v_mfma_f32_16x16x32_bf16 a[144:147], v[48:51], v[80:83], a[144:147]
    v_mfma_f32_16x16x32_bf16 a[168:171], v[48:51], v[84:87], a[168:171]
    v_perm_b32 v24, v228, v224, s60
    v_perm_b32 v25, v236, v232, s60
    v_perm_b32 v26, v244, v240, s60
    v_perm_b32 v27, v252, v248, s60
    v_mfma_f32_16x16x32_bf16 a[148:151], v[52:55], v[80:83], a[148:151]
    v_mfma_f32_16x16x32_bf16 a[172:175], v[52:55], v[84:87], a[172:175]
    v_perm_b32 v28, v228, v224, s61
    v_perm_b32 v29, v236, v232, s61
    v_perm_b32 v30, v244, v240, s61
    v_perm_b32 v31, v252, v248, s61
    v_mfma_f32_16x16x32_bf16 a[152:155], v[56:59], v[80:83], a[152:155]
    v_mfma_f32_16x16x32_bf16 a[176:179], v[56:59], v[84:87], a[176:179]
    v_perm_b32 v32, v229, v225, s60
    v_perm_b32 v33, v237, v233, s60
    v_perm_b32 v34, v245, v241, s60
    v_perm_b32 v35, v253, v249, s60
    v_mfma_f32_16x16x32_bf16 a[156:159], v[60:63], v[80:83], a[156:159]
    v_mfma_f32_16x16x32_bf16 a[180:183], v[60:63], v[84:87], a[180:183]
    v_perm_b32 v36, v229, v225, s61
    v_perm_b32 v37, v237, v233, s61
    v_perm_b32 v38, v245, v241, s61
    v_perm_b32 v39, v253, v249, s61
    v_mfma_f32_16x16x32_bf16 a[160:163], v[64:67], v[80:83], a[160:163]
    v_mfma_f32_16x16x32_bf16 a[184:187], v[64:67], v[84:87], a[184:187]
    v_perm_b32 v40, v230, v226, s60
    v_perm_b32 v41, v238, v234, s60
    v_perm_b32 v42, v246, v242, s60
    v_perm_b32 v43, v254, v250, s60
    v_mfma_f32_16x16x32_bf16 a[164:167], v[68:71], v[80:83], a[164:167]
    v_mfma_f32_16x16x32_bf16 a[188:191], v[68:71], v[84:87], a[188:191]
    v_perm_b32 v44, v230, v226, s61
    v_perm_b32 v45, v238, v234, s61
    v_perm_b32 v46, v246, v242, s61
    v_perm_b32 v47, v254, v250, s61
    v_add_u32 v6, s34, v1
    s_add_u32 s34, s34, 1024
    s_cmp_eq_u32 s34, 12288
    s_cselect_b32 s34, 0, s34
    ds_read_b128 v[80:83], v6 offset:0
    ds_read_b128 v[84:87], v6 offset:12288
    s_add_u32 s48, s47, s33
    s_add_u32 s33, s33, 73728
    s_cmp_eq_u32 s33, 884736
    s_cselect_b32 s33, 0, s33
    buffer_load_dwordx3 v[224:226], v10, s[56:59], s48 offen offset:0
    buffer_load_dwordx3 v[228:230], v10, s[56:59], s48 offen offset:2304
    buffer_load_dwordx3 v[232:234], v11, s[56:59], s48 offen offset:0
    buffer_load_dwordx3 v[236:238], v11, s[56:59], s48 offen offset:2304
    buffer_load_dwordx3 v[240:242], v12, s[56:59], s48 offen offset:0
    buffer_load_dwordx3 v[244:246], v12, s[56:59], s48 offen offset:2304
    buffer_load_dwordx3 v[248:250], v13, s[56:59], s48 offen offset:0
    buffer_load_dwordx3 v[252:254], v13, s[56:59], s48 offen offset:2304
    s_waitcnt vmcnt(32) lgkmcnt(2)
    v_mfma_f32_16x16x32_bf16 a[144:147], v[24:27], v[72:75], a[144:147]
    v_mfma_f32_16x16x32_bf16 a[168:171], v[24:27], v[76:79], a[168:171]
    v_perm_b32 v48, v100, v96, s60
    v_perm_b32 v49, v108, v104, s60
    v_perm_b32 v50, v116, v112, s60
pad7:
    s_cbranch_execz wretA
    v_perm_b32 v51, v124, v120, s60
    v_mfma_f32_16x16x32_bf16 a[148:151], v[28:31], v[72:75], a[148:151]
    v_mfma_f32_16x16x32_bf16 a[172:175], v[28:31], v[76:79], a[172:175]
    v_perm_b32 v52, v100, v96, s61
    v_perm_b32 v53, v108, v104, s61
    v_perm_b32 v54, v116, v112, s61
    v_perm_b32 v55, v124, v120, s61
    v_mfma_f32_16x16x32_bf16 a[152:155], v[32:35], v[72:75], a[152:155]
    v_mfma_f32_16x16x32_bf16 a[176:179], v[32:35], v[76:79], a[176:179]
    v_perm_b32 v56, v101, v97, s60
    v_perm_b32 v57, v109, v105, s60
    v_perm_b32 v58, v117, v113, s60
    v_perm_b32 v59, v125, v121, s60
    v_mfma_f32_16x16x32_bf16 a[156:159], v[36:39], v[72:75], a[156:159]
    v_mfma_f32_16x16x32_bf16 a[180:183], v[36:39], v[76:79], a[180:183]
    v_perm_b32 v60, v101, v97, s61
    v_perm_b32 v61, v109, v105, s61
    v_perm_b32 v62, v117, v113, s61
    v_perm_b32 v63, v125, v121, s61
    v_mfma_f32_16x16x32_bf16 a[160:163], v[40:43], v[72:75], a[160:163]
    v_mfma_f32_16x16x32_bf16 a[184:187], v[40:43], v[76:79], a[184:187]
    v_perm_b32 v64, v102, v98, s60
    v_perm_b32 v65, v110, v106, s60
    v_perm_b32 v66, v118, v114, s60
    v_perm_b32 v67, v126, v122, s60
    v_mfma_f32_16x16x32_bf16 a[164:167], v[44:47], v[72:75], a[164:167]
    v_mfma_f32_16x16x32_bf16 a[188:191], v[44:47], v[76:79], a[188:191]
    v_perm_b32 v68, v102, v98, s61
    v_perm_b32 v69, v110, v106, s61
    v_perm_b32 v70, v118, v114, s61
    v_perm_b32 v71, v126, v122, s61
    v_add_u32 v6, s34, v1
    s_add_u32 s34, s34, 1024
    s_cmp_eq_u32 s34, 12288
    s_cselect_b32 s34, 0, s34
    ds_read_b128 v[72:75], v6 offset:0
    ds_read_b128 v[76:79], v6 offset:12288
    s_add_u32 s48, s47, s33
    s_add_u32 s33, s33, 73728
    s_cmp_eq_u32 s33, 884736
    s_cselect_b32 s33, 0, s33
    buffer_load_dwordx3 v[96:98], v10, s[56:59], s48 offen offset:0
    buffer_load_dwordx3 v[100:102], v10, s[56:59], s48 offen offset:2304
    buffer_load_dwordx3 v[104:106], v11, s[56:59], s48 offen offset:0
    buffer_load_dwordx3 v[108:110], v11, s[56:59], s48 offen offset:2304
    buffer_load_dwordx3 v[112:114], v12, s[56:59], s48 offen offset:0
    buffer_load_dwordx3 v[116:118], v12, s[56:59], s48 offen offset:2304
    buffer_load_dwordx3 v[120:122], v13, s[56:59], s48 offen offset:0
    buffer_load_dwordx3 v[124:126], v13, s[56:59], s48 offen offset:2304
    s_waitcnt vmcnt(32) lgkmcnt(2)
    v_mfma_f32_16x16x32_bf16 a[144:147], v[48:51], v[80:83], a[144:147]
    v_mfma_f32_16x16x32_bf16 a[168:171], v[48:51], v[84:87], a[168:171]
    v_perm_b32 v24, v132, v128, s60
    v_perm_b32 v25, v140, v136, s60
    v_perm_b32 v26, v148, v144, s60
    v_perm_b32 v27, v156, v152, s60
    v_mfma_f32_16x16x32_bf16 a[148:151], v[52:55], v[80:83], a[148:151]
    v_mfma_f32_16x16x32_bf16 a[172:175], v[52:55], v[84:87], a[172:175]
    v_perm_b32 v28, v132, v128, s61
    v_perm_b32 v29, v140, v136, s61
    v_perm_b32 v30, v148, v144, s61
    v_perm_b32 v31, v156, v152, s61
    v_mfma_f32_16x16x32_bf16 a[152:155], v[56:59], v[80:83], a[152:155]
    v_mfma_f32_16x16x32_bf16 a[176:179], v[56:59], v[84:87], a[176:179]
    v_perm_b32 v32, v133, v129, s60
pad8:
    s_cbranch_execz wretA
    v_perm_b32 v33, v141, v137, s60
    v_perm_b32 v34, v149, v145, s60
    v_perm_b32 v35, v157, v153, s60
    v_mfma_f32_16x16x32_bf16 a[156:159], v[60:63], v[80:83], a[156:159]
    v_mfma_f32_16x16x32_bf16 a[180:183], v[60:63], v[84:87], a[180:183]
    v_perm_b32 v36, v133, v129, s61
    v_perm_b32 v37, v141, v137, s61
    v_perm_b32 v38, v149, v145, s61
    v_perm_b32 v39, v157, v153, s61
    v_mfma_f32_16x16x32_bf16 a[160:163], v[64:67], v[80:83], a[160:163]
    v_mfma_f32_16x16x32_bf16 a[184:187], v[64:67], v[84:87], a[184:187]
    v_perm_b32 v40, v134, v130, s60
    v_perm_b32 v41, v142, v138, s60
    v_perm_b32 v42, v150, v146, s60
    v_perm_b32 v43, v158, v154, s60
    v_mfma_f32_16x16x32_bf16 a[164:167], v[68:71], v[80:83], a[164:167]
    v_mfma_f32_16x16x32_bf16 a[188:191], v[68:71], v[84:87], a[188:191]
    v_perm_b32 v44, v134, v130, s61
    v_perm_b32 v45, v142, v138, s61
    v_perm_b32 v46, v150, v146, s61
    v_perm_b32 v47, v158, v154, s61
    v_add_u32 v6, s34, v1
    s_add_u32 s34, s34, 1024
    s_cmp_eq_u32 s34, 12288
    s_cselect_b32 s34, 0, s34
    ds_read_b128 v[80:83], v6 offset:0
    ds_read_b128 v[84:87], v6 offset:12288
    s_add_u32 s48, s47, s33
    s_add_u32 s33, s33, 73728
    s_cmp_eq_u32 s33, 884736
    s_cselect_b32 s33, 0, s33
    buffer_load_dwordx3 v[128:130], v10, s[56:59], s48 offen offset:0
    buffer_load_dwordx3 v[132:134], v10, s[56:59], s48 offen offset:2304
    buffer_load_dwordx3 v[136:138], v11, s[56:59], s48 offen offset:0
    buffer_load_dwordx3 v[140:142], v11, s[56:59], s48 offen offset:2304
    buffer_load_dwordx3 v[144:146], v12, s[56:59], s48 offen offset:0
    buffer_load_dwordx3 v[148:150], v12, s[56:59], s48 offen offset:2304
    buffer_load_dwordx3 v[152:154], v13, s[56:59], s48 offen offset:0
    buffer_load_dwordx3 v[156:158], v13, s[56:59], s48 offen offset:2304
    s_waitcnt vmcnt(32) lgkmcnt(2)
    v_mfma_f32_16x16x32_bf16 a[144:147], v[24:27], v[72:75], a[144:147]
    v_mfma_f32_16x16x32_bf16 a[168:171], v[24:27], v[76:79], a[168:171]
    v_perm_b32 v48, v164, v160, s60
    v_perm_b32 v49, v172, v168, s60
    v_perm_b32 v50, v180, v176, s60
    v_perm_b32 v51, v188, v184, s60
    v_mfma_f32_16x16x32_bf16 a[148:151], v[28:31], v[72:75], a[148:151]
    v_mfma_f32_16x16x32_bf16 a[172:175], v[28:31], v[76:79], a[172:175]
    v_perm_b32 v52, v164, v160, s61
    v_perm_b32 v53, v172, v168, s61
    v_perm_b32 v54, v180, v176, s61
    v_perm_b32 v55, v188, v184, s61
    v_mfma_f32_16x16x32_bf16 a[152:155], v[32:35], v[72:75], a[152:155]
    v_mfma_f32_16x16x32_bf16 a[176:179], v[32:35], v[76:79], a[176:179]
    v_perm_b32 v56, v165, v161, s60
    v_perm_b32 v57, v173, v169, s60
    v_perm_b32 v58, v181, v177, s60
    v_perm_b32 v59, v189, v185, s60
    v_mfma_f32_16x16x32_bf16 a[156:159], v[36:39], v[72:75], a[156:159]
    v_mfma_f32_16x16x32_bf16 a[180:183], v[36:39], v[76:79], a[180:183]
    v_perm_b32 v60, v165, v161, s61
    v_perm_b32 v61, v173, v169, s61
    v_perm_b32 v62, v181, v177, s61
    v_perm_b32 v63, v189, v185, s61
    v_mfma_f32_16x16x32_bf16 a[160:163], v[40:43], v[72:75], a[160:163]
pad9:
    s_cbranch_execz wretA
    v_mfma_f32_16x16x32_bf16 a[184:187], v[40:43], v[76:79], a[184:187]
    v_perm_b32 v64, v166, v162, s60
    v_perm_b32 v65, v174, v170, s60
    v_perm_b32 v66, v182, v178, s60
    v_perm_b32 v67, v190, v186, s60
    v_mfma_f32_16x16x32_bf16 a[164:167], v[44:47], v[72:75], a[164:167]
    v_mfma_f32_16x16x32_bf16 a[188:191], v[44:47], v[76:79], a[188:191]
    v_perm_b32 v68, v166, v162, s61
    v_perm_b32 v69, v174, v170, s61
    v_perm_b32 v70, v182, v178, s61
    v_perm_b32 v71, v190, v186, s61
    v_add_u32 v6, s34, v1
    s_add_u32 s34, s34, 1024
    s_cmp_eq_u32 s34, 12288
    s_cselect_b32 s34, 0, s34
    ds_read_b128 v[72:75], v6 offset:0
    ds_read_b128 v[76:79], v6 offset:12288
    s_waitcnt vmcnt(24) lgkmcnt(2)
    v_mfma_f32_16x16x32_bf16 a[144:147], v[48:51], v[80:83], a[144:147]
    v_mfma_f32_16x16x32_bf16 a[168:171], v[48:51], v[84:87], a[168:171]
    v_perm_b32 v24, v196, v192, s60
    v_perm_b32 v25, v204, v200, s60
    v_perm_b32 v26, v212, v208, s60
    v_perm_b32 v27, v220, v216, s60
    v_mfma_f32_16x16x32_bf16 a[148:151], v[52:55], v[80:83], a[148:151]
    v_mfma_f32_16x16x32_bf16 a[172:175], v[52:55], v[84:87], a[172:175]
    v_perm_b32 v28, v196, v192, s61
    v_perm_b32 v29, v204, v200, s61
    v_perm_b32 v30, v212, v208, s61
    v_perm_b32 v31, v220, v216, s61
    v_mfma_f32_16x16x32_bf16 a[152:155], v[56:59], v[80:83], a[152:155]
    v_mfma_f32_16x16x32_bf16 a[176:179], v[56:59], v[84:87], a[176:179]
    v_perm_b32 v32, v197, v193, s60
    v_perm_b32 v33, v205, v201, s60
    v_perm_b32 v34, v213, v209, s60
    v_perm_b32 v35, v221, v217, s60
    v_mfma_f32_16x16x32_bf16 a[156:159], v[60:63], v[80:83], a[156:159]
    v_mfma_f32_16x16x32_bf16 a[180:183], v[60:63], v[84:87], a[180:183]
    v_perm_b32 v36, v197, v193, s61
    v_perm_b32 v37, v205, v201, s61
    v_perm_b32 v38, v213, v209, s61
    v_perm_b32 v39, v221, v217, s61
    v_mfma_f32_16x16x32_bf16 a[160:163], v[64:67], v[80:83], a[160:163]
    v_mfma_f32_16x16x32_bf16 a[184:187], v[64:67], v[84:87], a[184:187]
    v_perm_b32 v40, v198, v194, s60
    v_perm_b32 v41, v206, v202, s60
    v_perm_b32 v42, v214, v210, s60
    v_perm_b32 v43, v222, v218, s60
    v_mfma_f32_16x16x32_bf16 a[164:167], v[68:71], v[80:83], a[164:167]
    v_mfma_f32_16x16x32_bf16 a[188:191], v[68:71], v[84:87], a[188:191]
    v_perm_b32 v44, v198, v194, s61
    v_perm_b32 v45, v206, v202, s61
    v_perm_b32 v46, v214, v210, s61
    v_perm_b32 v47, v222, v218, s61
    v_add_u32 v6, s34, v1
    s_add_u32 s34, s34, 1024
    s_cmp_eq_u32 s34, 12288
    s_cselect_b32 s34, 0, s34
    ds_read_b128 v[80:83], v6 offset:0
    ds_read_b128 v[84:87], v6 offset:12288
    s_waitcnt vmcnt(16) lgkmcnt(2)
    v_mfma_f32_16x16x32_bf16 a[144:147], v[24:27], v[72:75], a[144:147]
    v_mfma_f32_16x16x32_bf16 a[168:171], v[24:27], v[76:79], a[168:171]
    v_perm_b32 v48, v228, v224, s60
    v_perm_b32 v49, v236, v232, s60
    v_perm_b32 v50, v244, v240, s60
pad10:
    s_cbranch_execz wretA
    v_perm_b32 v51, v252, v248, s60
    v_mfma_f32_16x16x32_bf16 a[148:151], v[28:31], v[72:75], a[148:151]
    v_mfma_f32_16x16x32_bf16 a[172:175], v[28:31], v[76:79], a[172:175]
    v_perm_b32 v52, v228, v224, s61
    v_perm_b32 v53, v236, v232, s61
    v_perm_b32 v54, v244, v240, s61
    v_perm_b32 v55, v252, v248, s61
    v_mfma_f32_16x16x32_bf16 a[152:155], v[32:35], v[72:75], a[152:155]
    v_mfma_f32_16x16x32_bf16 a[176:179], v[32:35], v[76:79], a[176:179]
    v_perm_b32 v56, v229, v225, s60
    v_perm_b32 v57, v237, v233, s60
    v_perm_b32 v58, v245, v241, s60
    v_perm_b32 v59, v253, v249, s60
    v_mfma_f32_16x16x32_bf16 a[156:159], v[36:39], v[72:75], a[156:159]
    v_mfma_f32_16x16x32_bf16 a[180:183], v[36:39], v[76:79], a[180:183]
    v_perm_b32 v60, v229, v225, s61
    v_perm_b32 v61, v237, v233, s61
    v_perm_b32 v62, v245, v241, s61
    v_perm_b32 v63, v253, v249, s61
    v_mfma_f32_16x16x32_bf16 a[160:163], v[40:43], v[72:75], a[160:163]
    v_mfma_f32_16x16x32_bf16 a[184:187], v[40:43], v[76:79], a[184:187]
    v_perm_b32 v64, v230, v226, s60
    v_perm_b32 v65, v238, v234, s60
    v_perm_b32 v66, v246, v242, s60
    v_perm_b32 v67, v254, v250, s60
    v_mfma_f32_16x16x32_bf16 a[164:167], v[44:47], v[72:75], a[164:167]
    v_mfma_f32_16x16x32_bf16 a[188:191], v[44:47], v[76:79], a[188:191]
    v_perm_b32 v68, v230, v226, s61
    v_perm_b32 v69, v238, v234, s61
    v_perm_b32 v70, v246, v242, s61
    v_perm_b32 v71, v254, v250, s61
    v_add_u32 v6, s34, v1
    s_add_u32 s34, s34, 1024
    s_cmp_eq_u32 s34, 12288
    s_cselect_b32 s34, 0, s34
    ds_read_b128 v[72:75], v6 offset:0
    ds_read_b128 v[76:79], v6 offset:12288
    s_waitcnt vmcnt(8) lgkmcnt(2)
    v_mfma_f32_16x16x32_bf16 a[144:147], v[48:51], v[80:83], a[144:147]
    v_mfma_f32_16x16x32_bf16 a[168:171], v[48:51], v[84:87], a[168:171]
    v_perm_b32 v24, v100, v96, s60
    v_perm_b32 v25, v108, v104, s60
    v_perm_b32 v26, v116, v112, s60
    v_perm_b32 v27, v124, v120, s60
    v_mfma_f32_16x16x32_bf16 a[148:151], v[52:55], v[80:83], a[148:151]
    v_mfma_f32_16x16x32_bf16 a[172:175], v[52:55], v[84:87], a[172:175]
    v_perm_b32 v28, v100, v96, s61
    v_perm_b32 v29, v108, v104, s61
    v_perm_b32 v30, v116, v112, s61
    v_perm_b32 v31, v124, v120, s61
    v_mfma_f32_16x16x32_bf16 a[152:155], v[56:59], v[80:83], a[152:155]
    v_mfma_f32_16x16x32_bf16 a[176:179], v[56:59], v[84:87], a[176:179]
    v_perm_b32 v32, v101, v97, s60
    v_perm_b32 v33, v109, v105, s60
    v_perm_b32 v34, v117, v113, s60
    v_perm_b32 v35, v125, v121, s60
    v_mfma_f32_16x16x32_bf16 a[156:159], v[60:63], v[80:83], a[156:159]
    v_mfma_f32_16x16x32_bf16 a[180:183], v[60:63], v[84:87], a[180:183]
    v_perm_b32 v36, v101, v97, s61
    v_perm_b32 v37, v109, v105, s61
    v_perm_b32 v38, v117, v113, s61
    v_perm_b32 v39, v125, v121, s61
    v_mfma_f32_16x16x32_bf16 a[160:163], v[64:67], v[80:83], a[160:163]
    v_mfma_f32_16x16x32_bf16 a[184:187], v[64:67], v[84:87], a[184:187]
    v_perm_b32 v40, v102, v98, s60
pad11:
    s_cbranch_execz wretA
    v_perm_b32 v41, v110, v106, s60
    v_perm_b32 v42, v118, v114, s60
    v_perm_b32 v43, v126, v122, s60
    v_mfma_f32_16x16x32_bf16 a[164:167], v[68:71], v[80:83], a[164:167]
    v_mfma_f32_16x16x32_bf16 a[188:191], v[68:71], v[84:87], a[188:191]
    v_perm_b32 v44, v102, v98, s61
    v_perm_b32 v45, v110, v106, s61
    v_perm_b32 v46, v118, v114, s61
    v_perm_b32 v47, v126, v122, s61
    v_add_u32 v6, s34, v1
    s_add_u32 s34, s34, 1024
    s_cmp_eq_u32 s34, 12288
    s_cselect_b32 s34, 0, s34
    ds_read_b128 v[80:83], v6 offset:0
    ds_read_b128 v[84:87], v6 offset:12288
    s_waitcnt vmcnt(0) lgkmcnt(2)
    v_mfma_f32_16x16x32_bf16 a[144:147], v[24:27], v[72:75], a[144:147]
    v_mfma_f32_16x16x32_bf16 a[168:171], v[24:27], v[76:79], a[168:171]
    v_perm_b32 v48, v132, v128, s60
    v_perm_b32 v49, v140, v136, s60
    v_perm_b32 v50, v148, v144, s60
    v_perm_b32 v51, v156, v152, s60
    v_mfma_f32_16x16x32_bf16 a[148:151], v[28:31], v[72:75], a[148:151]
    v_mfma_f32_16x16x32_bf16 a[172:175], v[28:31], v[76:79], a[172:175]
    v_perm_b32 v52, v132, v128, s61
    v_perm_b32 v53, v140, v136, s61
    v_perm_b32 v54, v148, v144, s61
    v_perm_b32 v55, v156, v152, s61
    v_mfma_f32_16x16x32_bf16 a[152:155], v[32:35], v[72:75], a[152:155]
    v_mfma_f32_16x16x32_bf16 a[176:179], v[32:35], v[76:79], a[176:179]
    v_perm_b32 v56, v133, v129, s60
    v_perm_b32 v57, v141, v137, s60
    v_perm_b32 v58, v149, v145, s60
    v_perm_b32 v59, v157, v153, s60
    v_mfma_f32_16x16x32_bf16 a[156:159], v[36:39], v[72:75], a[156:159]
    v_mfma_f32_16x16x32_bf16 a[180:183], v[36:39], v[76:79], a[180:183]
    v_perm_b32 v60, v133, v129, s61
    v_perm_b32 v61, v141, v137, s61
    v_perm_b32 v62, v149, v145, s61
    v_perm_b32 v63, v157, v153, s61
    v_mfma_f32_16x16x32_bf16 a[160:163], v[40:43], v[72:75], a[160:163]
    v_mfma_f32_16x16x32_bf16 a[184:187], v[40:43], v[76:79], a[184:187]
    v_perm_b32 v64, v134, v130, s60
    v_perm_b32 v65, v142, v138, s60
    v_perm_b32 v66, v150, v146, s60
    v_perm_b32 v67, v158, v154, s60
    v_mfma_f32_16x16x32_bf16 a[164:167], v[44:47], v[72:75], a[164:167]
    v_mfma_f32_16x16x32_bf16 a[188:191], v[44:47], v[76:79], a[188:191]
    v_perm_b32 v68, v134, v130, s61
    v_perm_b32 v69, v142, v138, s61
    v_perm_b32 v70, v150, v146, s61
    v_perm_b32 v71, v158, v154, s61
    s_waitcnt lgkmcnt(0)
    v_mfma_f32_16x16x32_bf16 a[144:147], v[48:51], v[80:83], a[144:147]
    v_mfma_f32_16x16x32_bf16 a[168:171], v[48:51], v[84:87], a[168:171]
    v_mfma_f32_16x16x32_bf16 a[148:151], v[52:55], v[80:83], a[148:151]
    v_mfma_f32_16x16x32_bf16 a[172:175], v[52:55], v[84:87], a[172:175]
    v_mfma_f32_16x16x32_bf16 a[152:155], v[56:59], v[80:83], a[152:155]
    v_mfma_f32_16x16x32_bf16 a[176:179], v[56:59], v[84:87], a[176:179]
    v_mfma_f32_16x16x32_bf16 a[156:159], v[60:63], v[80:83], a[156:159]
    v_mfma_f32_16x16x32_bf16 a[180:183], v[60:63], v[84:87], a[180:183]
    v_mfma_f32_16x16x32_bf16 a[160:163], v[64:67], v[80:83], a[160:163]
    v_mfma_f32_16x16x32_bf16 a[184:187], v[64:67], v[84:87], a[184:187]
    v_mfma_f32_16x16x32_bf16 a[164:167], v[68:71], v[80:83], a[164:167]
    v_mfma_f32_16x16x32_bf16 a[188:191], v[68:71], v[84:87], a[188:191]
    s_nop 7
pad12:
    s_cbranch_execz wretA
    v_accvgpr_read_b32 v96, a144
    v_accvgpr_read_b32 v97, a145
    v_accvgpr_read_b32 v98, a146
    v_accvgpr_read_b32 v99, a147
    v_accvgpr_read_b32 v100, a148
    v_accvgpr_read_b32 v101, a149
    v_accvgpr_read_b32 v102, a150
    v_accvgpr_read_b32 v103, a151
    v_accvgpr_read_b32 v104, a152
    v_accvgpr_read_b32 v105, a153
    v_accvgpr_read_b32 v106, a154
    v_accvgpr_read_b32 v107, a155
    v_accvgpr_read_b32 v108, a156
    v_accvgpr_read_b32 v109, a157
    v_accvgpr_read_b32 v110, a158
    v_accvgpr_read_b32 v111, a159
    v_accvgpr_read_b32 v112, a160
    v_accvgpr_read_b32 v113, a161
    v_accvgpr_read_b32 v114, a162
    v_accvgpr_read_b32 v115, a163
    v_accvgpr_read_b32 v116, a164
    v_accvgpr_read_b32 v117, a165
    v_accvgpr_read_b32 v118, a166
    v_accvgpr_read_b32 v119, a167
    v_accvgpr_read_b32 v120, a168
    v_accvgpr_read_b32 v121, a169
    v_accvgpr_read_b32 v122, a170
    v_accvgpr_read_b32 v123, a171
    v_accvgpr_read_b32 v124, a172
    v_accvgpr_read_b32 v125, a173
    v_accvgpr_read_b32 v126, a174
    v_accvgpr_read_b32 v127, a175
    v_accvgpr_read_b32 v128, a176
    v_accvgpr_read_b32 v129, a177
    v_accvgpr_read_b32 v130, a178
    v_accvgpr_read_b32 v131, a179
    v_accvgpr_read_b32 v132, a180
    v_accvgpr_read_b32 v133, a181
    v_accvgpr_read_b32 v134, a182
    v_accvgpr_read_b32 v135, a183
    v_accvgpr_read_b32 v136, a184
    v_accvgpr_read_b32 v137, a185
    v_accvgpr_read_b32 v138, a186
    v_accvgpr_read_b32 v139, a187
    v_accvgpr_read_b32 v140, a188
    v_accvgpr_read_b32 v141, a189
    v_accvgpr_read_b32 v142, a190
    v_accvgpr_read_b32 v143, a191
    v_cvt_pk_bf16_f32 v24, v96, v97
    v_cvt_pk_bf16_f32 v25, v98, v99
    v_cvt_pk_bf16_f32 v26, v100, v101
    v_cvt_pk_bf16_f32 v27, v102, v103
    v_cvt_pk_bf16_f32 v28, v104, v105
    v_cvt_pk_bf16_f32 v29, v106, v107
    v_cvt_pk_bf16_f32 v30, v108, v109
    v_cvt_pk_bf16_f32 v31, v110, v111
    v_cvt_pk_bf16_f32 v32, v112, v113
    v_cvt_pk_bf16_f32 v33, v114, v115
    v_cvt_pk_bf16_f32 v34, v116, v117
    v_cvt_pk_bf16_f32 v35, v118, v119
    v_cvt_pk_bf16_f32 v36, v120, v121
    v_cvt_pk_bf16_f32 v37, v122, v123
    v_cvt_pk_bf16_f32 v38, v124, v125
    v_cvt_pk_bf16_f32 v39, v126, v127
pad13:
    s_cbranch_execz wretA
    v_cvt_pk_bf16_f32 v40, v128, v129
    v_cvt_pk_bf16_f32 v41, v130, v131
    v_cvt_pk_bf16_f32 v42, v132, v133
    v_cvt_pk_bf16_f32 v43, v134, v135
    v_cvt_pk_bf16_f32 v44, v136, v137
    v_cvt_pk_bf16_f32 v45, v138, v139
    v_cvt_pk_bf16_f32 v46, v140, v141
    v_cvt_pk_bf16_f32 v47, v142, v143
    s_mul_i32 s42, s3, 6144
    s_add_u32 s42, s42, 24576
    v_add_u32 v6, s42, v1
    ds_write_b128 v6, v[24:27] offset:0
    ds_write_b128 v6, v[28:31] offset:1024
    ds_write_b128 v6, v[32:35] offset:2048
    ds_write_b128 v6, v[36:39] offset:3072
    ds_write_b128 v6, v[40:43] offset:4096
    ds_write_b128 v6, v[44:47] offset:5120
    s_waitcnt lgkmcnt(0)
    s_barrier
    s_branch p1_spin
p1_v:
    v_add_u32 v6, s34, v1
    s_add_u32 s34, s34, 1024
    s_cmp_eq_u32 s34, 12288
    s_cselect_b32 s34, 0, s34
    ds_read_b128 v[72:75], v6 offset:0
    ds_read_b128 v[76:79], v6 offset:12288
    s_waitcnt vmcnt(32)
    v_perm_b32 v24, v100, v96, s60
    v_perm_b32 v25, v108, v104, s60
    v_perm_b32 v26, v116, v112, s60
    v_perm_b32 v27, v124, v120, s60
    v_perm_b32 v28, v100, v96, s61
    v_perm_b32 v29, v108, v104, s61
    v_perm_b32 v30, v116, v112, s61
    v_perm_b32 v31, v124, v120, s61
    v_perm_b32 v32, v101, v97, s60
    v_perm_b32 v33, v109, v105, s60
    v_perm_b32 v34, v117, v113, s60
    v_perm_b32 v35, v125, v121, s60
    v_perm_b32 v36, v101, v97, s61
    v_perm_b32 v37, v109, v105, s61
    v_perm_b32 v38, v117, v113, s61
    v_perm_b32 v39, v125, v121, s61
    v_perm_b32 v40, v102, v98, s60
    v_perm_b32 v41, v110, v106, s60
    v_perm_b32 v42, v118, v114, s60
    v_perm_b32 v43, v126, v122, s60
    v_perm_b32 v44, v102, v98, s61
    v_perm_b32 v45, v110, v106, s61
    v_perm_b32 v46, v118, v114, s61
    v_perm_b32 v47, v126, v122, s61
    v_add_u32 v6, s34, v1
    s_add_u32 s34, s34, 1024
    s_cmp_eq_u32 s34, 12288
    s_cselect_b32 s34, 0, s34
    ds_read_b128 v[80:83], v6 offset:0
    ds_read_b128 v[84:87], v6 offset:12288
    s_add_u32 s48, s47, s33
    s_add_u32 s33, s33, 73728
    s_cmp_eq_u32 s33, 884736
    s_cselect_b32 s33, 0, s33
    buffer_load_dwordx3 v[96:98], v10, s[56:59], s48 offen offset:0
    buffer_load_dwordx3 v[100:102], v10, s[56:59], s48 offen offset:2304
    buffer_load_dwordx3 v[104:106], v11, s[56:59], s48 offen offset:0
    buffer_load_dwordx3 v[108:110], v11, s[56:59], s48 offen offset:2304
    buffer_load_dwordx3 v[112:114], v12, s[56:59], s48 offen offset:0
    buffer_load_dwordx3 v[116:118], v12, s[56:59], s48 offen offset:2304
pad14:
    s_cbranch_execz wretA
    buffer_load_dwordx3 v[120:122], v13, s[56:59], s48 offen offset:0
    buffer_load_dwordx3 v[124:126], v13, s[56:59], s48 offen offset:2304
    s_waitcnt vmcnt(32) lgkmcnt(2)
    v_mfma_f32_16x16x32_bf16 a[144:147], v[72:75], v[24:27], 0
    v_mfma_f32_16x16x32_bf16 a[168:171], v[76:79], v[24:27], 0
    v_perm_b32 v48, v132, v128, s60
    v_perm_b32 v49, v140, v136, s60
    v_perm_b32 v50, v148, v144, s60
    v_perm_b32 v51, v156, v152, s60
    v_mfma_f32_16x16x32_bf16 a[148:151], v[72:75], v[28:31], 0
    v_mfma_f32_16x16x32_bf16 a[172:175], v[76:79], v[28:31], 0
    v_perm_b32 v52, v132, v128, s61
    v_perm_b32 v53, v140, v136, s61
    v_perm_b32 v54, v148, v144, s61
    v_perm_b32 v55, v156, v152, s61
    v_mfma_f32_16x16x32_bf16 a[152:155], v[72:75], v[32:35], 0
    v_mfma_f32_16x16x32_bf16 a[176:179], v[76:79], v[32:35], 0
    v_perm_b32 v56, v133, v129, s60
    v_perm_b32 v57, v141, v137, s60
    v_perm_b32 v58, v149, v145, s60
    v_perm_b32 v59, v157, v153, s60
    v_mfma_f32_16x16x32_bf16 a[156:159], v[72:75], v[36:39], 0
    v_mfma_f32_16x16x32_bf16 a[180:183], v[76:79], v[36:39], 0
    v_perm_b32 v60, v133, v129, s61
    v_perm_b32 v61, v141, v137, s61
    v_perm_b32 v62, v149, v145, s61
    v_perm_b32 v63, v157, v153, s61
    v_mfma_f32_16x16x32_bf16 a[160:163], v[72:75], v[40:43], 0
    v_mfma_f32_16x16x32_bf16 a[184:187], v[76:79], v[40:43], 0
    v_perm_b32 v64, v134, v130, s60
    v_perm_b32 v65, v142, v138, s60
    v_perm_b32 v66, v150, v146, s60
    v_perm_b32 v67, v158, v154, s60
    v_mfma_f32_16x16x32_bf16 a[164:167], v[72:75], v[44:47], 0
    v_mfma_f32_16x16x32_bf16 a[188:191], v[76:79], v[44:47], 0
    v_perm_b32 v68, v134, v130, s61
    v_perm_b32 v69, v142, v138, s61
    v_perm_b32 v70, v150, v146, s61
    v_perm_b32 v71, v158, v154, s61
    v_add_u32 v6, s34, v1
    s_add_u32 s34, s34, 1024
    s_cmp_eq_u32 s34, 12288
    s_cselect_b32 s34, 0, s34
    ds_read_b128 v[72:75], v6 offset:0
    ds_read_b128 v[76:79], v6 offset:12288
    s_add_u32 s48, s47, s33
    s_add_u32 s33, s33, 73728
    s_cmp_eq_u32 s33, 884736
    s_cselect_b32 s33, 0, s33
    buffer_load_dwordx3 v[128:130], v10, s[56:59], s48 offen offset:0
    buffer_load_dwordx3 v[132:134], v10, s[56:59], s48 offen offset:2304
    buffer_load_dwordx3 v[136:138], v11, s[56:59], s48 offen offset:0
    buffer_load_dwordx3 v[140:142], v11, s[56:59], s48 offen offset:2304
    buffer_load_dwordx3 v[144:146], v12, s[56:59], s48 offen offset:0
    buffer_load_dwordx3 v[148:150], v12, s[56:59], s48 offen offset:2304
    buffer_load_dwordx3 v[152:154], v13, s[56:59], s48 offen offset:0
    buffer_load_dwordx3 v[156:158], v13, s[56:59], s48 offen offset:2304
    s_waitcnt vmcnt(32) lgkmcnt(2)
    v_mfma_f32_16x16x32_bf16 a[144:147], v[80:83], v[48:51], a[144:147]
    v_mfma_f32_16x16x32_bf16 a[168:171], v[84:87], v[48:51], a[168:171]
    v_perm_b32 v24, v164, v160, s60
    v_perm_b32 v25, v172, v168, s60
    v_perm_b32 v26, v180, v176, s60
    v_perm_b32 v27, v188, v184, s60
    v_mfma_f32_16x16x32_bf16 a[148:151], v[80:83], v[52:55], a[148:151]
pad15:
    s_cbranch_execz wretA
    v_mfma_f32_16x16x32_bf16 a[172:175], v[84:87], v[52:55], a[172:175]
    v_perm_b32 v28, v164, v160, s61
    v_perm_b32 v29, v172, v168, s61
    v_perm_b32 v30, v180, v176, s61
    v_perm_b32 v31, v188, v184, s61
    v_mfma_f32_16x16x32_bf16 a[152:155], v[80:83], v[56:59], a[152:155]
    v_mfma_f32_16x16x32_bf16 a[176:179], v[84:87], v[56:59], a[176:179]
    v_perm_b32 v32, v165, v161, s60
    v_perm_b32 v33, v173, v169, s60
    v_perm_b32 v34, v181, v177, s60
    v_perm_b32 v35, v189, v185, s60
    v_mfma_f32_16x16x32_bf16 a[156:159], v[80:83], v[60:63], a[156:159]
    v_mfma_f32_16x16x32_bf16 a[180:183], v[84:87], v[60:63], a[180:183]
    v_perm_b32 v36, v165, v161, s61
    v_perm_b32 v37, v173, v169, s61
    v_perm_b32 v38, v181, v177, s61
    v_perm_b32 v39, v189, v185, s61
    v_mfma_f32_16x16x32_bf16 a[160:163], v[80:83], v[64:67], a[160:163]
    v_mfma_f32_16x16x32_bf16 a[184:187], v[84:87], v[64:67], a[184:187]
    v_perm_b32 v40, v166, v162, s60
    v_perm_b32 v41, v174, v170, s60
    v_perm_b32 v42, v182, v178, s60
    v_perm_b32 v43, v190, v186, s60
    v_mfma_f32_16x16x32_bf16 a[164:167], v[80:83], v[68:71], a[164:167]
    v_mfma_f32_16x16x32_bf16 a[188:191], v[84:87], v[68:71], a[188:191]
    v_perm_b32 v44, v166, v162, s61
    v_perm_b32 v45, v174, v170, s61
    v_perm_b32 v46, v182, v178, s61
    v_perm_b32 v47, v190, v186, s61
    v_add_u32 v6, s34, v1
    s_add_u32 s34, s34, 1024
    s_cmp_eq_u32 s34, 12288
    s_cselect_b32 s34, 0, s34
    ds_read_b128 v[80:83], v6 offset:0
    ds_read_b128 v[84:87], v6 offset:12288
    s_add_u32 s48, s47, s33
    s_add_u32 s33, s33, 73728
    s_cmp_eq_u32 s33, 884736
    s_cselect_b32 s33, 0, s33
    buffer_load_dwordx3 v[160:162], v10, s[56:59], s48 offen offset:0
    buffer_load_dwordx3 v[164:166], v10, s[56:59], s48 offen offset:2304
    buffer_load_dwordx3 v[168:170], v11, s[56:59], s48 offen offset:0
    buffer_load_dwordx3 v[172:174], v11, s[56:59], s48 offen offset:2304
    buffer_load_dwordx3 v[176:178], v12, s[56:59], s48 offen offset:0
    buffer_load_dwordx3 v[180:182], v12, s[56:59], s48 offen offset:2304
    buffer_load_dwordx3 v[184:186], v13, s[56:59], s48 offen offset:0
    buffer_load_dwordx3 v[188:190], v13, s[56:59], s48 offen offset:2304
    s_waitcnt vmcnt(32) lgkmcnt(2)
    v_mfma_f32_16x16x32_bf16 a[144:147], v[72:75], v[24:27], a[144:147]
    v_mfma_f32_16x16x32_bf16 a[168:171], v[76:79], v[24:27], a[168:171]
    v_perm_b32 v48, v196, v192, s60
    v_perm_b32 v49, v204, v200, s60
    v_perm_b32 v50, v212, v208, s60
    v_perm_b32 v51, v220, v216, s60
    v_mfma_f32_16x16x32_bf16 a[148:151], v[72:75], v[28:31], a[148:151]
    v_mfma_f32_16x16x32_bf16 a[172:175], v[76:79], v[28:31], a[172:175]
    v_perm_b32 v52, v196, v192, s61
    v_perm_b32 v53, v204, v200, s61
    v_perm_b32 v54, v212, v208, s61
    v_perm_b32 v55, v220, v216, s61
    v_mfma_f32_16x16x32_bf16 a[152:155], v[72:75], v[32:35], a[152:155]
    v_mfma_f32_16x16x32_bf16 a[176:179], v[76:79], v[32:35], a[176:179]
    v_perm_b32 v56, v197, v193, s60
    v_perm_b32 v57, v205, v201, s60
    v_perm_b32 v58, v213, v209, s60
pad16:
    s_cbranch_execz wretA
    v_perm_b32 v59, v221, v217, s60
    v_mfma_f32_16x16x32_bf16 a[156:159], v[72:75], v[36:39], a[156:159]
    v_mfma_f32_16x16x32_bf16 a[180:183], v[76:79], v[36:39], a[180:183]
    v_perm_b32 v60, v197, v193, s61
    v_perm_b32 v61, v205, v201, s61
    v_perm_b32 v62, v213, v209, s61
    v_perm_b32 v63, v221, v217, s61
    v_mfma_f32_16x16x32_bf16 a[160:163], v[72:75], v[40:43], a[160:163]
    v_mfma_f32_16x16x32_bf16 a[184:187], v[76:79], v[40:43], a[184:187]
    v_perm_b32 v64, v198, v194, s60
    v_perm_b32 v65, v206, v202, s60
    v_perm_b32 v66, v214, v210, s60
    v_perm_b32 v67, v222, v218, s60
    v_mfma_f32_16x16x32_bf16 a[164:167], v[72:75], v[44:47], a[164:167]
    v_mfma_f32_16x16x32_bf16 a[188:191], v[76:79], v[44:47], a[188:191]
    v_perm_b32 v68, v198, v194, s61
    v_perm_b32 v69, v206, v202, s61
    v_perm_b32 v70, v214, v210, s61
    v_perm_b32 v71, v222, v218, s61
    v_add_u32 v6, s34, v1
    s_add_u32 s34, s34, 1024
    s_cmp_eq_u32 s34, 12288
    s_cselect_b32 s34, 0, s34
    ds_read_b128 v[72:75], v6 offset:0
    ds_read_b128 v[76:79], v6 offset:12288
    s_add_u32 s48, s47, s33
    s_add_u32 s33, s33, 73728
    s_cmp_eq_u32 s33, 884736
    s_cselect_b32 s33, 0, s33
    buffer_load_dwordx3 v[192:194], v10, s[56:59], s48 offen offset:0
    buffer_load_dwordx3 v[196:198], v10, s[56:59], s48 offen offset:2304
    buffer_load_dwordx3 v[200:202], v11, s[56:59], s48 offen offset:0
    buffer_load_dwordx3 v[204:206], v11, s[56:59], s48 offen offset:2304
    buffer_load_dwordx3 v[208:210], v12, s[56:59], s48 offen offset:0
    buffer_load_dwordx3 v[212:214], v12, s[56:59], s48 offen offset:2304
    buffer_load_dwordx3 v[216:218], v13, s[56:59], s48 offen offset:0
    buffer_load_dwordx3 v[220:222], v13, s[56:59], s48 offen offset:2304
    s_waitcnt vmcnt(32) lgkmcnt(2)
    v_mfma_f32_16x16x32_bf16 a[144:147], v[80:83], v[48:51], a[144:147]
    v_mfma_f32_16x16x32_bf16 a[168:171], v[84:87], v[48:51], a[168:171]
    v_perm_b32 v24, v228, v224, s60
    v_perm_b32 v25, v236, v232, s60
    v_perm_b32 v26, v244, v240, s60
    v_perm_b32 v27, v252, v248, s60
    v_mfma_f32_16x16x32_bf16 a[148:151], v[80:83], v[52:55], a[148:151]
    v_mfma_f32_16x16x32_bf16 a[172:175], v[84:87], v[52:55], a[172:175]
    v_perm_b32 v28, v228, v224, s61
    v_perm_b32 v29, v236, v232, s61
    v_perm_b32 v30, v244, v240, s61
    v_perm_b32 v31, v252, v248, s61
    v_mfma_f32_16x16x32_bf16 a[152:155], v[80:83], v[56:59], a[152:155]
    v_mfma_f32_16x16x32_bf16 a[176:179], v[84:87], v[56:59], a[176:179]
    v_perm_b32 v32, v229, v225, s60
    v_perm_b32 v33, v237, v233, s60
    v_perm_b32 v34, v245, v241, s60
    v_perm_b32 v35, v253, v249, s60
    v_mfma_f32_16x16x32_bf16 a[156:159], v[80:83], v[60:63], a[156:159]
    v_mfma_f32_16x16x32_bf16 a[180:183], v[84:87], v[60:63], a[180:183]
    v_perm_b32 v36, v229, v225, s61
    v_perm_b32 v37, v237, v233, s61
    v_perm_b32 v38, v245, v241, s61
    v_perm_b32 v39, v253, v249, s61
    v_mfma_f32_16x16x32_bf16 a[160:163], v[80:83], v[64:67], a[160:163]
    v_mfma_f32_16x16x32_bf16 a[184:187], v[84:87], v[64:67], a[184:187]
    v_perm_b32 v40, v230, v226, s60
pad17:
    s_cbranch_execz wretA
    v_perm_b32 v41, v238, v234, s60
    v_perm_b32 v42, v246, v242, s60
    v_perm_b32 v43, v254, v250, s60
    v_mfma_f32_16x16x32_bf16 a[164:167], v[80:83], v[68:71], a[164:167]
    v_mfma_f32_16x16x32_bf16 a[188:191], v[84:87], v[68:71], a[188:191]
    v_perm_b32 v44, v230, v226, s61
    v_perm_b32 v45, v238, v234, s61
    v_perm_b32 v46, v246, v242, s61
    v_perm_b32 v47, v254, v250, s61
    v_add_u32 v6, s34, v1
    s_add_u32 s34, s34, 1024
    s_cmp_eq_u32 s34, 12288
    s_cselect_b32 s34, 0, s34
    ds_read_b128 v[80:83], v6 offset:0
    ds_read_b128 v[84:87], v6 offset:12288
    s_add_u32 s48, s47, s33
    s_add_u32 s33, s33, 73728
    s_cmp_eq_u32 s33, 884736
    s_cselect_b32 s33, 0, s33
    buffer_load_dwordx3 v[224:226], v10, s[56:59], s48 offen offset:0
    buffer_load_dwordx3 v[228:230], v10, s[56:59], s48 offen offset:2304
    buffer_load_dwordx3 v[232:234], v11, s[56:59], s48 offen offset:0
    buffer_load_dwordx3 v[236:238], v11, s[56:59], s48 offen offset:2304
    buffer_load_dwordx3 v[240:242], v12, s[56:59], s48 offen offset:0
    buffer_load_dwordx3 v[244:246], v12, s[56:59], s48 offen offset:2304
    buffer_load_dwordx3 v[248:250], v13, s[56:59], s48 offen offset:0
    buffer_load_dwordx3 v[252:254], v13, s[56:59], s48 offen offset:2304
    s_waitcnt vmcnt(32) lgkmcnt(2)
    v_mfma_f32_16x16x32_bf16 a[144:147], v[72:75], v[24:27], a[144:147]
    v_mfma_f32_16x16x32_bf16 a[168:171], v[76:79], v[24:27], a[168:171]
    v_perm_b32 v48, v100, v96, s60
    v_perm_b32 v49, v108, v104, s60
    v_perm_b32 v50, v116, v112, s60
    v_perm_b32 v51, v124, v120, s60
    v_mfma_f32_16x16x32_bf16 a[148:151], v[72:75], v[28:31], a[148:151]
    v_mfma_f32_16x16x32_bf16 a[172:175], v[76:79], v[28:31], a[172:175]
    v_perm_b32 v52, v100, v96, s61
    v_perm_b32 v53, v108, v104, s61
    v_perm_b32 v54, v116, v112, s61
    v_perm_b32 v55, v124, v120, s61
    v_mfma_f32_16x16x32_bf16 a[152:155], v[72:75], v[32:35], a[152:155]
    v_mfma_f32_16x16x32_bf16 a[176:179], v[76:79], v[32:35], a[176:179]
    v_perm_b32 v56, v101, v97, s60
    v_perm_b32 v57, v109, v105, s60
    v_perm_b32 v58, v117, v113, s60
    v_perm_b32 v59, v125, v121, s60
    v_mfma_f32_16x16x32_bf16 a[156:159], v[72:75], v[36:39], a[156:159]
    v_mfma_f32_16x16x32_bf16 a[180:183], v[76:79], v[36:39], a[180:183]
    v_perm_b32 v60, v101, v97, s61
    v_perm_b32 v61, v109, v105, s61
    v_perm_b32 v62, v117, v113, s61
    v_perm_b32 v63, v125, v121, s61
    v_mfma_f32_16x16x32_bf16 a[160:163], v[72:75], v[40:43], a[160:163]
    v_mfma_f32_16x16x32_bf16 a[184:187], v[76:79], v[40:43], a[184:187]
    v_perm_b32 v64, v102, v98, s60
    v_perm_b32 v65, v110, v106, s60
    v_perm_b32 v66, v118, v114, s60
    v_perm_b32 v67, v126, v122, s60
    v_mfma_f32_16x16x32_bf16 a[164:167], v[72:75], v[44:47], a[164:167]
    v_mfma_f32_16x16x32_bf16 a[188:191], v[76:79], v[44:47], a[188:191]
    v_perm_b32 v68, v102, v98, s61
    v_perm_b32 v69, v110, v106, s61
    v_perm_b32 v70, v118, v114, s61
    v_perm_b32 v71, v126, v122, s61
    v_add_u32 v6, s34, v1
pad18:
    s_cbranch_execz wretA
    s_add_u32 s34, s34, 1024
    s_cmp_eq_u32 s34, 12288
    s_cselect_b32 s34, 0, s34
    ds_read_b128 v[72:75], v6 offset:0
    ds_read_b128 v[76:79], v6 offset:12288
    s_add_u32 s48, s47, s33
    s_add_u32 s33, s33, 73728
    s_cmp_eq_u32 s33, 884736
    s_cselect_b32 s33, 0, s33
    buffer_load_dwordx3 v[96:98], v10, s[56:59], s48 offen offset:0
    buffer_load_dwordx3 v[100:102], v10, s[56:59], s48 offen offset:2304
    buffer_load_dwordx3 v[104:106], v11, s[56:59], s48 offen offset:0
    buffer_load_dwordx3 v[108:110], v11, s[56:59], s48 offen offset:2304
    buffer_load_dwordx3 v[112:114], v12, s[56:59], s48 offen offset:0
    buffer_load_dwordx3 v[116:118], v12, s[56:59], s48 offen offset:2304
    buffer_load_dwordx3 v[120:122], v13, s[56:59], s48 offen offset:0
    buffer_load_dwordx3 v[124:126], v13, s[56:59], s48 offen offset:2304
    s_waitcnt vmcnt(32) lgkmcnt(2)
    v_mfma_f32_16x16x32_bf16 a[144:147], v[80:83], v[48:51], a[144:147]
    v_mfma_f32_16x16x32_bf16 a[168:171], v[84:87], v[48:51], a[168:171]
    v_perm_b32 v24, v132, v128, s60
    v_perm_b32 v25, v140, v136, s60
    v_perm_b32 v26, v148, v144, s60
    v_perm_b32 v27, v156, v152, s60
    v_mfma_f32_16x16x32_bf16 a[148:151], v[80:83], v[52:55], a[148:151]
    v_mfma_f32_16x16x32_bf16 a[172:175], v[84:87], v[52:55], a[172:175]
    v_perm_b32 v28, v132, v128, s61
    v_perm_b32 v29, v140, v136, s61
    v_perm_b32 v30, v148, v144, s61
    v_perm_b32 v31, v156, v152, s61
    v_mfma_f32_16x16x32_bf16 a[152:155], v[80:83], v[56:59], a[152:155]
    v_mfma_f32_16x16x32_bf16 a[176:179], v[84:87], v[56:59], a[176:179]
    v_perm_b32 v32, v133, v129, s60
    v_perm_b32 v33, v141, v137, s60
    v_perm_b32 v34, v149, v145, s60
    v_perm_b32 v35, v157, v153, s60
    v_mfma_f32_16x16x32_bf16 a[156:159], v[80:83], v[60:63], a[156:159]
    v_mfma_f32_16x16x32_bf16 a[180:183], v[84:87], v[60:63], a[180:183]
    v_perm_b32 v36, v133, v129, s61
    v_perm_b32 v37, v141, v137, s61
    v_perm_b32 v38, v149, v145, s61
    v_perm_b32 v39, v157, v153, s61
    v_mfma_f32_16x16x32_bf16 a[160:163], v[80:83], v[64:67], a[160:163]
    v_mfma_f32_16x16x32_bf16 a[184:187], v[84:87], v[64:67], a[184:187]
    v_perm_b32 v40, v134, v130, s60
    v_perm_b32 v41, v142, v138, s60
    v_perm_b32 v42, v150, v146, s60
    v_perm_b32 v43, v158, v154, s60
    v_mfma_f32_16x16x32_bf16 a[164:167], v[80:83], v[68:71], a[164:167]
    v_mfma_f32_16x16x32_bf16 a[188:191], v[84:87], v[68:71], a[188:191]
    v_perm_b32 v44, v134, v130, s61
    v_perm_b32 v45, v142, v138, s61
    v_perm_b32 v46, v150, v146, s61
    v_perm_b32 v47, v158, v154, s61
    v_add_u32 v6, s34, v1
    s_add_u32 s34, s34, 1024
    s_cmp_eq_u32 s34, 12288
    s_cselect_b32 s34, 0, s34
    ds_read_b128 v[80:83], v6 offset:0
    ds_read_b128 v[84:87], v6 offset:12288
    s_add_u32 s48, s47, s33
    s_add_u32 s33, s33, 73728
    s_cmp_eq_u32 s33, 884736
    s_cselect_b32 s33, 0, s33
    buffer_load_dwordx3 v[128:130], v10, s[56:59], s48 offen offset:0
pad19:
    s_cbranch_execz wretA
    buffer_load_dwordx3 v[132:134], v10, s[56:59], s48 offen offset:2304
    buffer_load_dwordx3 v[136:138], v11, s[56:59], s48 offen offset:0
    buffer_load_dwordx3 v[140:142], v11, s[56:59], s48 offen offset:2304
    buffer_load_dwordx3 v[144:146], v12, s[56:59], s48 offen offset:0
    buffer_load_dwordx3 v[148:150], v12, s[56:59], s48 offen offset:2304
    buffer_load_dwordx3 v[152:154], v13, s[56:59], s48 offen offset:0
    buffer_load_dwordx3 v[156:158], v13, s[56:59], s48 offen offset:2304
    s_waitcnt vmcnt(32) lgkmcnt(2)
    v_mfma_f32_16x16x32_bf16 a[144:147], v[72:75], v[24:27], a[144:147]
    v_mfma_f32_16x16x32_bf16 a[168:171], v[76:79], v[24:27], a[168:171]
    v_perm_b32 v48, v164, v160, s60
    v_perm_b32 v49, v172, v168, s60
    v_perm_b32 v50, v180, v176, s60
    v_perm_b32 v51, v188, v184, s60
    v_mfma_f32_16x16x32_bf16 a[148:151], v[72:75], v[28:31], a[148:151]
    v_mfma_f32_16x16x32_bf16 a[172:175], v[76:79], v[28:31], a[172:175]
    v_perm_b32 v52, v164, v160, s61
    v_perm_b32 v53, v172, v168, s61
    v_perm_b32 v54, v180, v176, s61
    v_perm_b32 v55, v188, v184, s61
    v_mfma_f32_16x16x32_bf16 a[152:155], v[72:75], v[32:35], a[152:155]
    v_mfma_f32_16x16x32_bf16 a[176:179], v[76:79], v[32:35], a[176:179]
    v_perm_b32 v56, v165, v161, s60
    v_perm_b32 v57, v173, v169, s60
    v_perm_b32 v58, v181, v177, s60
    v_perm_b32 v59, v189, v185, s60
    v_mfma_f32_16x16x32_bf16 a[156:159], v[72:75], v[36:39], a[156:159]
    v_mfma_f32_16x16x32_bf16 a[180:183], v[76:79], v[36:39], a[180:183]
    v_perm_b32 v60, v165, v161, s61
    v_perm_b32 v61, v173, v169, s61
    v_perm_b32 v62, v181, v177, s61
    v_perm_b32 v63, v189, v185, s61
    v_mfma_f32_16x16x32_bf16 a[160:163], v[72:75], v[40:43], a[160:163]
    v_mfma_f32_16x16x32_bf16 a[184:187], v[76:79], v[40:43], a[184:187]
    v_perm_b32 v64, v166, v162, s60
    v_perm_b32 v65, v174, v170, s60
    v_perm_b32 v66, v182, v178, s60
    v_perm_b32 v67, v190, v186, s60
    v_mfma_f32_16x16x32_bf16 a[164:167], v[72:75], v[44:47], a[164:167]
    v_mfma_f32_16x16x32_bf16 a[188:191], v[76:79], v[44:47], a[188:191]
    v_perm_b32 v68, v166, v162, s61
    v_perm_b32 v69, v174, v170, s61
    v_perm_b32 v70, v182, v178, s61
    v_perm_b32 v71, v190, v186, s61
    v_add_u32 v6, s34, v1
    s_add_u32 s34, s34, 1024
    s_cmp_eq_u32 s34, 12288
    s_cselect_b32 s34, 0, s34
    ds_read_b128 v[72:75], v6 offset:0
    ds_read_b128 v[76:79], v6 offset:12288
    s_waitcnt vmcnt(24) lgkmcnt(2)
    v_mfma_f32_16x16x32_bf16 a[144:147], v[80:83], v[48:51], a[144:147]
    v_mfma_f32_16x16x32_bf16 a[168:171], v[84:87], v[48:51], a[168:171]
    v_perm_b32 v24, v196, v192, s60
    v_perm_b32 v25, v204, v200, s60
    v_perm_b32 v26, v212, v208, s60
    v_perm_b32 v27, v220, v216, s60
    v_mfma_f32_16x16x32_bf16 a[148:151], v[80:83], v[52:55], a[148:151]
    v_mfma_f32_16x16x32_bf16 a[172:175], v[84:87], v[52:55], a[172:175]
    v_perm_b32 v28, v196, v192, s61
    v_perm_b32 v29, v204, v200, s61
    v_perm_b32 v30, v212, v208, s61
    v_perm_b32 v31, v220, v216, s61
    v_mfma_f32_16x16x32_bf16 a[152:155], v[80:83], v[56:59], a[152:155]
    v_mfma_f32_16x16x32_bf16 a[176:179], v[84:87], v[56:59], a[176:179]
pad20:
    s_cbranch_execz wretA
    v_perm_b32 v32, v197, v193, s60
    v_perm_b32 v33, v205, v201, s60
    v_perm_b32 v34, v213, v209, s60
    v_perm_b32 v35, v221, v217, s60
    v_mfma_f32_16x16x32_bf16 a[156:159], v[80:83], v[60:63], a[156:159]
    v_mfma_f32_16x16x32_bf16 a[180:183], v[84:87], v[60:63], a[180:183]
    v_perm_b32 v36, v197, v193, s61
    v_perm_b32 v37, v205, v201, s61
    v_perm_b32 v38, v213, v209, s61
    v_perm_b32 v39, v221, v217, s61
    v_mfma_f32_16x16x32_bf16 a[160:163], v[80:83], v[64:67], a[160:163]
    v_mfma_f32_16x16x32_bf16 a[184:187], v[84:87], v[64:67], a[184:187]
    v_perm_b32 v40, v198, v194, s60
    v_perm_b32 v41, v206, v202, s60
    v_perm_b32 v42, v214, v210, s60
    v_perm_b32 v43, v222, v218, s60
    v_mfma_f32_16x16x32_bf16 a[164:167], v[80:83], v[68:71], a[164:167]
    v_mfma_f32_16x16x32_bf16 a[188:191], v[84:87], v[68:71], a[188:191]
    v_perm_b32 v44, v198, v194, s61
    v_perm_b32 v45, v206, v202, s61
    v_perm_b32 v46, v214, v210, s61
    v_perm_b32 v47, v222, v218, s61
    v_add_u32 v6, s34, v1
    s_add_u32 s34, s34, 1024
    s_cmp_eq_u32 s34, 12288
    s_cselect_b32 s34, 0, s34
    ds_read_b128 v[80:83], v6 offset:0
    ds_read_b128 v[84:87], v6 offset:12288
    s_waitcnt vmcnt(16) lgkmcnt(2)
    v_mfma_f32_16x16x32_bf16 a[144:147], v[72:75], v[24:27], a[144:147]
    v_mfma_f32_16x16x32_bf16 a[168:171], v[76:79], v[24:27], a[168:171]
    v_perm_b32 v48, v228, v224, s60
    v_perm_b32 v49, v236, v232, s60
    v_perm_b32 v50, v244, v240, s60
    v_perm_b32 v51, v252, v248, s60
    v_mfma_f32_16x16x32_bf16 a[148:151], v[72:75], v[28:31], a[148:151]
    v_mfma_f32_16x16x32_bf16 a[172:175], v[76:79], v[28:31], a[172:175]
    v_perm_b32 v52, v228, v224, s61
    v_perm_b32 v53, v236, v232, s61
    v_perm_b32 v54, v244, v240, s61
    v_perm_b32 v55, v252, v248, s61
    v_mfma_f32_16x16x32_bf16 a[152:155], v[72:75], v[32:35], a[152:155]
    v_mfma_f32_16x16x32_bf16 a[176:179], v[76:79], v[32:35], a[176:179]
    v_perm_b32 v56, v229, v225, s60
    v_perm_b32 v57, v237, v233, s60
    v_perm_b32 v58, v245, v241, s60
    v_perm_b32 v59, v253, v249, s60
    v_mfma_f32_16x16x32_bf16 a[156:159], v[72:75], v[36:39], a[156:159]
    v_mfma_f32_16x16x32_bf16 a[180:183], v[76:79], v[36:39], a[180:183]
    v_perm_b32 v60, v229, v225, s61
    v_perm_b32 v61, v237, v233, s61
    v_perm_b32 v62, v245, v241, s61
    v_perm_b32 v63, v253, v249, s61
    v_mfma_f32_16x16x32_bf16 a[160:163], v[72:75], v[40:43], a[160:163]
    v_mfma_f32_16x16x32_bf16 a[184:187], v[76:79], v[40:43], a[184:187]
    v_perm_b32 v64, v230, v226, s60
    v_perm_b32 v65, v238, v234, s60
    v_perm_b32 v66, v246, v242, s60
    v_perm_b32 v67, v254, v250, s60
    v_mfma_f32_16x16x32_bf16 a[164:167], v[72:75], v[44:47], a[164:167]
    v_mfma_f32_16x16x32_bf16 a[188:191], v[76:79], v[44:47], a[188:191]
    v_perm_b32 v68, v230, v226, s61
    v_perm_b32 v69, v238, v234, s61
    v_perm_b32 v70, v246, v242, s61
    v_perm_b32 v71, v254, v250, s61
pad21:
    s_cbranch_execz wretA
    v_add_u32 v6, s34, v1
    s_add_u32 s34, s34, 1024
    s_cmp_eq_u32 s34, 12288
    s_cselect_b32 s34, 0, s34
    ds_read_b128 v[72:75], v6 offset:0
    ds_read_b128 v[76:79], v6 offset:12288
    s_waitcnt vmcnt(8) lgkmcnt(2)
    v_mfma_f32_16x16x32_bf16 a[144:147], v[80:83], v[48:51], a[144:147]
    v_mfma_f32_16x16x32_bf16 a[168:171], v[84:87], v[48:51], a[168:171]
    v_perm_b32 v24, v100, v96, s60
    v_perm_b32 v25, v108, v104, s60
    v_perm_b32 v26, v116, v112, s60
    v_perm_b32 v27, v124, v120, s60
    v_mfma_f32_16x16x32_bf16 a[148:151], v[80:83], v[52:55], a[148:151]
    v_mfma_f32_16x16x32_bf16 a[172:175], v[84:87], v[52:55], a[172:175]
    v_perm_b32 v28, v100, v96, s61
    v_perm_b32 v29, v108, v104, s61
    v_perm_b32 v30, v116, v112, s61
    v_perm_b32 v31, v124, v120, s61
    v_mfma_f32_16x16x32_bf16 a[152:155], v[80:83], v[56:59], a[152:155]
    v_mfma_f32_16x16x32_bf16 a[176:179], v[84:87], v[56:59], a[176:179]
    v_perm_b32 v32, v101, v97, s60
    v_perm_b32 v33, v109, v105, s60
    v_perm_b32 v34, v117, v113, s60
    v_perm_b32 v35, v125, v121, s60
    v_mfma_f32_16x16x32_bf16 a[156:159], v[80:83], v[60:63], a[156:159]
    v_mfma_f32_16x16x32_bf16 a[180:183], v[84:87], v[60:63], a[180:183]
    v_perm_b32 v36, v101, v97, s61
    v_perm_b32 v37, v109, v105, s61
    v_perm_b32 v38, v117, v113, s61
    v_perm_b32 v39, v125, v121, s61
    v_mfma_f32_16x16x32_bf16 a[160:163], v[80:83], v[64:67], a[160:163]
    v_mfma_f32_16x16x32_bf16 a[184:187], v[84:87], v[64:67], a[184:187]
    v_perm_b32 v40, v102, v98, s60
    v_perm_b32 v41, v110, v106, s60
    v_perm_b32 v42, v118, v114, s60
    v_perm_b32 v43, v126, v122, s60
    v_mfma_f32_16x16x32_bf16 a[164:167], v[80:83], v[68:71], a[164:167]
    v_mfma_f32_16x16x32_bf16 a[188:191], v[84:87], v[68:71], a[188:191]
    v_perm_b32 v44, v102, v98, s61
    v_perm_b32 v45, v110, v106, s61
    v_perm_b32 v46, v118, v114, s61
    v_perm_b32 v47, v126, v122, s61
    v_add_u32 v6, s34, v1
    s_add_u32 s34, s34, 1024
    s_cmp_eq_u32 s34, 12288
    s_cselect_b32 s34, 0, s34
    ds_read_b128 v[80:83], v6 offset:0
    ds_read_b128 v[84:87], v6 offset:12288
    s_waitcnt vmcnt(0) lgkmcnt(2)
    v_mfma_f32_16x16x32_bf16 a[144:147], v[72:75], v[24:27], a[144:147]
    v_mfma_f32_16x16x32_bf16 a[168:171], v[76:79], v[24:27], a[168:171]
    v_perm_b32 v48, v132, v128, s60
    v_perm_b32 v49, v140, v136, s60
    v_perm_b32 v50, v148, v144, s60
    v_perm_b32 v51, v156, v152, s60
    v_mfma_f32_16x16x32_bf16 a[148:151], v[72:75], v[28:31], a[148:151]
    v_mfma_f32_16x16x32_bf16 a[172:175], v[76:79], v[28:31], a[172:175]
    v_perm_b32 v52, v132, v128, s61
    v_perm_b32 v53, v140, v136, s61
    v_perm_b32 v54, v148, v144, s61
    v_perm_b32 v55, v156, v152, s61
    v_mfma_f32_16x16x32_bf16 a[152:155], v[72:75], v[32:35], a[152:155]
    v_mfma_f32_16x16x32_bf16 a[176:179], v[76:79], v[32:35], a[176:179]
    v_perm_b32 v56, v133, v129, s60
pad22:
    s_cbranch_execz wretA
    v_perm_b32 v57, v141, v137, s60
    v_perm_b32 v58, v149, v145, s60
    v_perm_b32 v59, v157, v153, s60
    v_mfma_f32_16x16x32_bf16 a[156:159], v[72:75], v[36:39], a[156:159]
    v_mfma_f32_16x16x32_bf16 a[180:183], v[76:79], v[36:39], a[180:183]
    v_perm_b32 v60, v133, v129, s61
    v_perm_b32 v61, v141, v137, s61
    v_perm_b32 v62, v149, v145, s61
    v_perm_b32 v63, v157, v153, s61
    v_mfma_f32_16x16x32_bf16 a[160:163], v[72:75], v[40:43], a[160:163]
    v_mfma_f32_16x16x32_bf16 a[184:187], v[76:79], v[40:43], a[184:187]
    v_perm_b32 v64, v134, v130, s60
    v_perm_b32 v65, v142, v138, s60
    v_perm_b32 v66, v150, v146, s60
    v_perm_b32 v67, v158, v154, s60
    v_mfma_f32_16x16x32_bf16 a[164:167], v[72:75], v[44:47], a[164:167]
    v_mfma_f32_16x16x32_bf16 a[188:191], v[76:79], v[44:47], a[188:191]
    v_perm_b32 v68, v134, v130, s61
    v_perm_b32 v69, v142, v138, s61
    v_perm_b32 v70, v150, v146, s61
    v_perm_b32 v71, v158, v154, s61
    s_waitcnt lgkmcnt(0)
    v_mfma_f32_16x16x32_bf16 a[144:147], v[80:83], v[48:51], a[144:147]
    v_mfma_f32_16x16x32_bf16 a[168:171], v[84:87], v[48:51], a[168:171]
    v_mfma_f32_16x16x32_bf16 a[148:151], v[80:83], v[52:55], a[148:151]
    v_mfma_f32_16x16x32_bf16 a[172:175], v[84:87], v[52:55], a[172:175]
    v_mfma_f32_16x16x32_bf16 a[152:155], v[80:83], v[56:59], a[152:155]
    v_mfma_f32_16x16x32_bf16 a[176:179], v[84:87], v[56:59], a[176:179]
    v_mfma_f32_16x16x32_bf16 a[156:159], v[80:83], v[60:63], a[156:159]
    v_mfma_f32_16x16x32_bf16 a[180:183], v[84:87], v[60:63], a[180:183]
    v_mfma_f32_16x16x32_bf16 a[160:163], v[80:83], v[64:67], a[160:163]
    v_mfma_f32_16x16x32_bf16 a[184:187], v[84:87], v[64:67], a[184:187]
    v_mfma_f32_16x16x32_bf16 a[164:167], v[80:83], v[68:71], a[164:167]
    v_mfma_f32_16x16x32_bf16 a[188:191], v[84:87], v[68:71], a[188:191]
    s_nop 7
    v_accvgpr_read_b32 v96, a144
    v_accvgpr_read_b32 v97, a145
    v_accvgpr_read_b32 v98, a146
    v_accvgpr_read_b32 v99, a147
    v_accvgpr_read_b32 v100, a148
    v_accvgpr_read_b32 v101, a149
    v_accvgpr_read_b32 v102, a150
    v_accvgpr_read_b32 v103, a151
    v_accvgpr_read_b32 v104, a152
    v_accvgpr_read_b32 v105, a153
    v_accvgpr_read_b32 v106, a154
    v_accvgpr_read_b32 v107, a155
    v_accvgpr_read_b32 v108, a156
    v_accvgpr_read_b32 v109, a157
    v_accvgpr_read_b32 v110, a158
    v_accvgpr_read_b32 v111, a159
    v_accvgpr_read_b32 v112, a160
    v_accvgpr_read_b32 v113, a161
    v_accvgpr_read_b32 v114, a162
    v_accvgpr_read_b32 v115, a163
    v_accvgpr_read_b32 v116, a164
    v_accvgpr_read_b32 v117, a165
    v_accvgpr_read_b32 v118, a166
    v_accvgpr_read_b32 v119, a167
    v_accvgpr_read_b32 v120, a168
    v_accvgpr_read_b32 v121, a169
    v_accvgpr_read_b32 v122, a170
    v_accvgpr_read_b32 v123, a171
    v_accvgpr_read_b32 v124, a172
    v_accvgpr_read_b32 v125, a173
pad23:
    s_cbranch_execz wretA
    v_accvgpr_read_b32 v126, a174
    v_accvgpr_read_b32 v127, a175
    v_accvgpr_read_b32 v128, a176
    v_accvgpr_read_b32 v129, a177
    v_accvgpr_read_b32 v130, a178
    v_accvgpr_read_b32 v131, a179
    v_accvgpr_read_b32 v132, a180
    v_accvgpr_read_b32 v133, a181
    v_accvgpr_read_b32 v134, a182
    v_accvgpr_read_b32 v135, a183
    v_accvgpr_read_b32 v136, a184
    v_accvgpr_read_b32 v137, a185
    v_accvgpr_read_b32 v138, a186
    v_accvgpr_read_b32 v139, a187
    v_accvgpr_read_b32 v140, a188
    v_accvgpr_read_b32 v141, a189
    v_accvgpr_read_b32 v142, a190
    v_accvgpr_read_b32 v143, a191
    v_cvt_pk_bf16_f32 v24, v96, v97
    v_cvt_pk_bf16_f32 v25, v98, v99
    v_cvt_pk_bf16_f32 v26, v100, v101
    v_cvt_pk_bf16_f32 v27, v102, v103
    v_cvt_pk_bf16_f32 v28, v104, v105
    v_cvt_pk_bf16_f32 v29, v106, v107
    v_cvt_pk_bf16_f32 v30, v108, v109
    v_cvt_pk_bf16_f32 v31, v110, v111
    v_cvt_pk_bf16_f32 v32, v112, v113
    v_cvt_pk_bf16_f32 v33, v114, v115
    v_cvt_pk_bf16_f32 v34, v116, v117
    v_cvt_pk_bf16_f32 v35, v118, v119
    v_cvt_pk_bf16_f32 v36, v120, v121
    v_cvt_pk_bf16_f32 v37, v122, v123
    v_cvt_pk_bf16_f32 v38, v124, v125
    v_cvt_pk_bf16_f32 v39, v126, v127
    v_cvt_pk_bf16_f32 v40, v128, v129
    v_cvt_pk_bf16_f32 v41, v130, v131
    v_cvt_pk_bf16_f32 v42, v132, v133
    v_cvt_pk_bf16_f32 v43, v134, v135
    v_cvt_pk_bf16_f32 v44, v136, v137
    v_cvt_pk_bf16_f32 v45, v138, v139
    v_cvt_pk_bf16_f32 v46, v140, v141
    v_cvt_pk_bf16_f32 v47, v142, v143
    v_cmp_eq_u32 vcc, v20, v2
    s_barrier
    ds_read_b128 v[72:75], v1 offset:24576
    ds_read_b128 v[76:79], v1 offset:30720
    ds_read_b128 v[80:83], v1 offset:25600
    ds_read_b128 v[84:87], v1 offset:31744
    ds_read_b128 v[88:91], v1 offset:26624
    ds_read_b128 v[92:95], v1 offset:32768
    ds_read_b128 v[96:99], v1 offset:27648
    ds_read_b128 v[100:103], v1 offset:33792
    ds_read_b128 v[104:107], v1 offset:28672
    ds_read_b128 v[108:111], v1 offset:34816
    ds_read_b128 v[112:115], v1 offset:29696
    ds_read_b128 v[116:119], v1 offset:35840
    s_waitcnt lgkmcnt(6)
    v_mfma_f32_16x16x32_bf16 v[120:123], v[76:79], v[72:75], 0
    v_mfma_f32_16x16x32_bf16 v[120:123], v[84:87], v[80:83], v[120:123]
    v_mfma_f32_16x16x32_bf16 v[120:123], v[92:95], v[88:91], v[120:123]
    s_waitcnt lgkmcnt(0)
    v_mfma_f32_16x16x32_bf16 v[128:131], v[100:103], v[96:99], 0
    v_mfma_f32_16x16x32_bf16 v[128:131], v[108:111], v[104:107], v[128:131]
    v_mfma_f32_16x16x32_bf16 v[128:131], v[116:119], v[112:115], v[128:131]
    s_nop 4
    v_max3_f32 v124, v120, v121, v122
    v_max_f32 v124, v124, v123
pad24:
    s_cbranch_execz wretA
    v_sub_f32 v120, v120, v124
    v_mul_f32 v120, s49, v120
    v_exp_f32 v120, v120
    v_sub_f32 v121, v121, v124
    v_mul_f32 v121, s49, v121
    v_exp_f32 v121, v121
    v_sub_f32 v122, v122, v124
    v_mul_f32 v122, s49, v122
    v_exp_f32 v122, v122
    v_sub_f32 v123, v123, v124
    v_mul_f32 v123, s49, v123
    v_exp_f32 v123, v123
    s_nop 0
    v_add_f32 v124, v120, v121
    v_add_f32 v125, v122, v123
    v_add_f32 v124, v124, v125
    v_rcp_f32 v124, v124
    s_nop 0
    v_cndmask_b32 v124, 0, v124, vcc
    v_mul_f32 v120, v120, v124
    v_mul_f32 v121, v121, v124
    v_mul_f32 v122, v122, v124
    v_mul_f32 v123, v123, v124
    v_cvt_pk_bf16_f32 v126, v120, v121
    v_cvt_pk_bf16_f32 v127, v122, v123
    s_nop 1
    v_mfma_f32_16x16x16_bf16 v[136:139], v[24:25], v[126:127], 0
    v_mfma_f32_16x16x16_bf16 v[140:143], v[26:27], v[126:127], 0
    v_mfma_f32_16x16x16_bf16 v[144:147], v[28:29], v[126:127], 0
    v_mfma_f32_16x16x16_bf16 v[148:151], v[30:31], v[126:127], 0
    v_mfma_f32_16x16x16_bf16 v[152:155], v[32:33], v[126:127], 0
    v_mfma_f32_16x16x16_bf16 v[156:159], v[34:35], v[126:127], 0
    v_max3_f32 v132, v128, v129, v130
    v_max_f32 v132, v132, v131
    v_sub_f32 v128, v128, v132
    v_mul_f32 v128, s49, v128
    v_exp_f32 v128, v128
    v_sub_f32 v129, v129, v132
    v_mul_f32 v129, s49, v129
    v_exp_f32 v129, v129
    v_sub_f32 v130, v130, v132
    v_mul_f32 v130, s49, v130
    v_exp_f32 v130, v130
    v_sub_f32 v131, v131, v132
    v_mul_f32 v131, s49, v131
    v_exp_f32 v131, v131
    s_nop 0
    v_add_f32 v132, v128, v129
    v_add_f32 v133, v130, v131
    v_add_f32 v132, v132, v133
    v_rcp_f32 v132, v132
    s_nop 0
    v_cndmask_b32 v132, 0, v132, vcc
    v_mul_f32 v128, v128, v132
    v_mul_f32 v129, v129, v132
    v_mul_f32 v130, v130, v132
    v_mul_f32 v131, v131, v132
    v_cvt_pk_bf16_f32 v134, v128, v129
    v_cvt_pk_bf16_f32 v135, v130, v131
    s_nop 1
    v_mfma_f32_16x16x16_bf16 v[160:163], v[36:37], v[134:135], 0
    v_mfma_f32_16x16x16_bf16 v[164:167], v[38:39], v[134:135], 0
    v_mfma_f32_16x16x16_bf16 v[168:171], v[40:41], v[134:135], 0
    v_mfma_f32_16x16x16_bf16 v[172:175], v[42:43], v[134:135], 0
    v_mfma_f32_16x16x16_bf16 v[176:179], v[44:45], v[134:135], 0
    v_mfma_f32_16x16x16_bf16 v[180:183], v[46:47], v[134:135], 0
    s_nop 2
    v_cvt_pk_bf16_f32 v72, v136, v137
    v_cvt_pk_bf16_f32 v73, v138, v139
    v_cvt_pk_bf16_f32 v74, v140, v141
    v_cvt_pk_bf16_f32 v75, v142, v143
    buffer_store_dwordx4 v[72:75], v21, s[20:23], s50 offen offset:0 sc1
    v_cvt_pk_bf16_f32 v76, v144, v145
    v_cvt_pk_bf16_f32 v77, v146, v147
    v_cvt_pk_bf16_f32 v78, v148, v149
    v_cvt_pk_bf16_f32 v79, v150, v151
    buffer_store_dwordx4 v[76:79], v21, s[20:23], s50 offen offset:1024 sc1
    v_cvt_pk_bf16_f32 v80, v152, v153
    v_cvt_pk_bf16_f32 v81, v154, v155
    v_cvt_pk_bf16_f32 v82, v156, v157
    v_cvt_pk_bf16_f32 v83, v158, v159
    buffer_store_dwordx4 v[80:83], v21, s[20:23], s50 offen offset:2048 sc1
    v_cvt_pk_bf16_f32 v84, v160, v161
    v_cvt_pk_bf16_f32 v85, v162, v163
    v_cvt_pk_bf16_f32 v86, v164, v165
    v_cvt_pk_bf16_f32 v87, v166, v167
    buffer_store_dwordx4 v[84:87], v21, s[20:23], s50 offen offset:64 sc1
pad25:
    s_cbranch_execz wretA
    v_cvt_pk_bf16_f32 v88, v168, v169
    v_cvt_pk_bf16_f32 v89, v170, v171
    v_cvt_pk_bf16_f32 v90, v172, v173
    v_cvt_pk_bf16_f32 v91, v174, v175
    buffer_store_dwordx4 v[88:91], v21, s[20:23], s50 offen offset:1088 sc1
    v_cvt_pk_bf16_f32 v92, v176, v177
    v_cvt_pk_bf16_f32 v93, v178, v179
    v_cvt_pk_bf16_f32 v94, v180, v181
    v_cvt_pk_bf16_f32 v95, v182, v183
    buffer_store_dwordx4 v[92:95], v21, s[20:23], s50 offen offset:2112 sc1
    v_mov_b32 v6, 1
    v_lshlrev_b32 v7, 12, v0
    s_waitcnt vmcnt(0)
    s_mov_b64 exec, 15
    buffer_store_dword v6, v7, s[20:23], s51 offen sc1
    s_mov_b64 exec, -1
p1_spin:
    s_mov_b32 s43, 0x400000
p1_spl:
    ds_read_b32 v6, v18
    s_sub_u32 s43, s43, 1
    s_cbranch_scc1 p2_pre
    s_waitcnt lgkmcnt(0)
    v_cmp_ne_u32 vcc, 1, v6
    s_cbranch_vccz p2_pre
    s_sleep 1
    s_branch p1_spl
p1_w3:
    s_lshr_b32 s42, s2, 3
    s_mov_b64 exec, 0
    s_cmp_eq_u32 s42, 0
    s_cbranch_scc1 pad0
    s_cmp_eq_u32 s42, 1
    s_cbranch_scc1 pad1
    s_cmp_eq_u32 s42, 2
    s_cbranch_scc1 pad2
    s_cmp_eq_u32 s42, 3
    s_cbranch_scc1 pad3
    s_cmp_eq_u32 s42, 4
    s_cbranch_scc1 pad4
    s_cmp_eq_u32 s42, 5
    s_cbranch_scc1 pad5
    s_cmp_eq_u32 s42, 6
    s_cbranch_scc1 pad6
    s_cmp_eq_u32 s42, 7
    s_cbranch_scc1 pad7
    s_cmp_eq_u32 s42, 8
    s_cbranch_scc1 pad8
    s_cmp_eq_u32 s42, 9
    s_cbranch_scc1 pad9
    s_cmp_eq_u32 s42, 10
    s_cbranch_scc1 pad10
    s_cmp_eq_u32 s42, 11
    s_cbranch_scc1 pad11
    s_cmp_eq_u32 s42, 12
    s_cbranch_scc1 pad12
    s_cmp_eq_u32 s42, 13
    s_cbranch_scc1 pad13
    s_cmp_eq_u32 s42, 14
    s_cbranch_scc1 pad14
    s_cmp_eq_u32 s42, 15
    s_cbranch_scc1 pad15
    s_cmp_eq_u32 s42, 16
    s_cbranch_scc1 pad16
    s_cmp_eq_u32 s42, 17
    s_cbranch_scc1 pad17
    s_cmp_eq_u32 s42, 18
    s_cbranch_scc1 pad18
    s_cmp_eq_u32 s42, 19
    s_cbranch_scc1 pad19
    s_cmp_eq_u32 s42, 20
    s_cbranch_scc1 pad20
    s_cmp_eq_u32 s42, 21
    s_cbranch_scc1 pad21
    s_cmp_eq_u32 s42, 22
    s_cbranch_scc1 pad22
    s_cmp_eq_u32 s42, 23
    s_cbranch_scc1 pad23
    s_cmp_eq_u32 s42, 24
    s_cbranch_scc1 pad24
    s_cmp_eq_u32 s42, 25
    s_cbranch_scc1 pad25
    s_cmp_eq_u32 s42, 26
    s_cbranch_scc1 pad26
    s_cmp_eq_u32 s42, 27
    s_cbranch_scc1 pad27
    s_cmp_eq_u32 s42, 28
    s_cbranch_scc1 pad28
    s_cmp_eq_u32 s42, 29
    s_cbranch_scc1 pad29
    s_cmp_eq_u32 s42, 30
    s_cbranch_scc1 pad30
    s_cmp_eq_u32 s42, 31
    s_cbranch_scc1 pad31
wretA:
    s_mov_b64 exec, -1
    s_cmp_ge_u32 s2, 192
    s_cbranch_scc1 p1_h3
    s_waitcnt vmcnt(0)
    v_lshlrev_b32 v48, 16, v24
    v_and_b32 v49, 0xffff0000, v24
    v_lshlrev_b32 v50, 16, v25
    v_and_b32 v51, 0xffff0000, v25
    v_lshlrev_b32 v52, 16, v26
    v_and_b32 v53, 0xffff0000, v26
    v_lshlrev_b32 v54, 16, v27
    v_and_b32 v55, 0xffff0000, v27
    v_lshlrev_b32 v56, 16, v28
    v_and_b32 v57, 0xffff0000, v28
    v_lshlrev_b32 v58, 16, v29
    v_and_b32 v59, 0xffff0000, v29
    v_lshlrev_b32 v60, 16, v30
    v_and_b32 v61, 0xffff0000, v30
    v_lshlrev_b32 v62, 16, v31
    v_and_b32 v63, 0xffff0000, v31
    v_lshlrev_b32 v64, 16, v32
    v_and_b32 v65, 0xffff0000, v32
    v_lshlrev_b32 v66, 16, v33
    v_and_b32 v67, 0xffff0000, v33
    v_lshlrev_b32 v68, 16, v34
    v_and_b32 v69, 0xffff0000, v34
    v_lshlrev_b32 v70, 16, v35
    v_and_b32 v71, 0xffff0000, v35
    v_lshlrev_b32 v72, 16, v36
    v_and_b32 v73, 0xffff0000, v36
    v_lshlrev_b32 v74, 16, v37
    v_and_b32 v75, 0xffff0000, v37
    v_lshlrev_b32 v76, 16, v38
    v_and_b32 v77, 0xffff0000, v38
    v_lshlrev_b32 v78, 16, v39
    v_and_b32 v79, 0xffff0000, v39
    v_lshlrev_b32 v80, 16, v40
    v_and_b32 v81, 0xffff0000, v40
    v_lshlrev_b32 v82, 16, v41
    v_and_b32 v83, 0xffff0000, v41
    v_lshlrev_b32 v84, 16, v42
    v_and_b32 v85, 0xffff0000, v42
    v_lshlrev_b32 v86, 16, v43
    v_and_b32 v87, 0xffff0000, v43
    v_lshlrev_b32 v88, 16, v44
    v_and_b32 v89, 0xffff0000, v44
    v_lshlrev_b32 v90, 16, v45
    v_and_b32 v91, 0xffff0000, v45
    v_lshlrev_b32 v92, 16, v46
    v_and_b32 v93, 0xffff0000, v46
    v_lshlrev_b32 v94, 16, v47
    v_and_b32 v95, 0xffff0000, v47
    v_pk_add_f32 v[14:15], v[48:49], v[50:51]
    v_pk_add_f32 v[16:17], v[52:53], v[54:55]
    v_pk_add_f32 v[14:15], v[14:15], v[56:57]
    v_pk_add_f32 v[16:17], v[16:17], v[58:59]
    v_pk_add_f32 v[14:15], v[14:15], v[60:61]
pad26:
    s_cbranch_execz wretA
    v_pk_add_f32 v[16:17], v[16:17], v[62:63]
    v_pk_add_f32 v[14:15], v[14:15], v[64:65]
    v_pk_add_f32 v[16:17], v[16:17], v[66:67]
    v_pk_add_f32 v[14:15], v[14:15], v[68:69]
    v_pk_add_f32 v[16:17], v[16:17], v[70:71]
    v_pk_add_f32 v[14:15], v[14:15], v[72:73]
    v_pk_add_f32 v[16:17], v[16:17], v[74:75]
    v_pk_add_f32 v[14:15], v[14:15], v[76:77]
    v_pk_add_f32 v[16:17], v[16:17], v[78:79]
    v_pk_add_f32 v[14:15], v[14:15], v[80:81]
    v_pk_add_f32 v[16:17], v[16:17], v[82:83]
    v_pk_add_f32 v[14:15], v[14:15], v[84:85]
    v_pk_add_f32 v[16:17], v[16:17], v[86:87]
    v_pk_add_f32 v[14:15], v[14:15], v[88:89]
    v_pk_add_f32 v[16:17], v[16:17], v[90:91]
    v_pk_add_f32 v[14:15], v[14:15], v[92:93]
    v_pk_add_f32 v[16:17], v[16:17], v[94:95]
    v_pk_add_f32 v[14:15], v[14:15], v[16:17]
    v_add_f32 v14, v14, v15
    s_nop 1
    v_add_f32_dpp v14, v14, v14 quad_perm:[1,0,3,2] row_mask:0xf bank_mask:0xf
    s_nop 1
    v_add_f32_dpp v14, v14, v14 quad_perm:[2,3,0,1] row_mask:0xf bank_mask:0xf
    s_nop 1
    v_add_f32_dpp v14, v14, v14 row_half_mirror row_mask:0xf bank_mask:0xf
    v_mul_f32 v14, 0xbb2aaaab, v14
    v_mov_b32 v15, v14
    v_pk_add_f32 v[48:49], v[48:49], v[14:15]
    v_pk_add_f32 v[50:51], v[50:51], v[14:15]
    v_pk_add_f32 v[52:53], v[52:53], v[14:15]
    v_pk_add_f32 v[54:55], v[54:55], v[14:15]
    v_pk_add_f32 v[56:57], v[56:57], v[14:15]
    v_pk_add_f32 v[58:59], v[58:59], v[14:15]
    v_pk_add_f32 v[60:61], v[60:61], v[14:15]
    v_pk_add_f32 v[62:63], v[62:63], v[14:15]
    v_pk_add_f32 v[64:65], v[64:65], v[14:15]
    v_pk_add_f32 v[66:67], v[66:67], v[14:15]
    v_pk_add_f32 v[68:69], v[68:69], v[14:15]
    v_pk_add_f32 v[70:71], v[70:71], v[14:15]
    v_pk_add_f32 v[72:73], v[72:73], v[14:15]
    v_pk_add_f32 v[74:75], v[74:75], v[14:15]
    v_pk_add_f32 v[76:77], v[76:77], v[14:15]
    v_pk_add_f32 v[78:79], v[78:79], v[14:15]
    v_pk_add_f32 v[80:81], v[80:81], v[14:15]
    v_pk_add_f32 v[82:83], v[82:83], v[14:15]
    v_pk_add_f32 v[84:85], v[84:85], v[14:15]
    v_pk_add_f32 v[86:87], v[86:87], v[14:15]
    v_pk_add_f32 v[88:89], v[88:89], v[14:15]
    v_pk_add_f32 v[90:91], v[90:91], v[14:15]
    v_pk_add_f32 v[92:93], v[92:93], v[14:15]
    v_pk_add_f32 v[94:95], v[94:95], v[14:15]
    v_pk_mul_f32 v[14:15], v[48:49], v[48:49]
    v_pk_mul_f32 v[16:17], v[50:51], v[50:51]
    v_pk_fma_f32 v[14:15], v[52:53], v[52:53], v[14:15]
    v_pk_fma_f32 v[16:17], v[54:55], v[54:55], v[16:17]
    v_pk_fma_f32 v[14:15], v[56:57], v[56:57], v[14:15]
    v_pk_fma_f32 v[16:17], v[58:59], v[58:59], v[16:17]
    v_pk_fma_f32 v[14:15], v[60:61], v[60:61], v[14:15]
    v_pk_fma_f32 v[16:17], v[62:63], v[62:63], v[16:17]
    v_pk_fma_f32 v[14:15], v[64:65], v[64:65], v[14:15]
    v_pk_fma_f32 v[16:17], v[66:67], v[66:67], v[16:17]
    v_pk_fma_f32 v[14:15], v[68:69], v[68:69], v[14:15]
    v_pk_fma_f32 v[16:17], v[70:71], v[70:71], v[16:17]
    v_pk_fma_f32 v[14:15], v[72:73], v[72:73], v[14:15]
    v_pk_fma_f32 v[16:17], v[74:75], v[74:75], v[16:17]
    v_pk_fma_f32 v[14:15], v[76:77], v[76:77], v[14:15]
pad27:
    s_cbranch_execz wretA
    v_pk_fma_f32 v[16:17], v[78:79], v[78:79], v[16:17]
    v_pk_fma_f32 v[14:15], v[80:81], v[80:81], v[14:15]
    v_pk_fma_f32 v[16:17], v[82:83], v[82:83], v[16:17]
    v_pk_fma_f32 v[14:15], v[84:85], v[84:85], v[14:15]
    v_pk_fma_f32 v[16:17], v[86:87], v[86:87], v[16:17]
    v_pk_fma_f32 v[14:15], v[88:89], v[88:89], v[14:15]
    v_pk_fma_f32 v[16:17], v[90:91], v[90:91], v[16:17]
    v_pk_fma_f32 v[14:15], v[92:93], v[92:93], v[14:15]
    v_pk_fma_f32 v[16:17], v[94:95], v[94:95], v[16:17]
    v_pk_add_f32 v[14:15], v[14:15], v[16:17]
    v_add_f32 v14, v14, v15
    s_nop 1
    v_add_f32_dpp v14, v14, v14 quad_perm:[1,0,3,2] row_mask:0xf bank_mask:0xf
    s_nop 1
    v_add_f32_dpp v14, v14, v14 quad_perm:[2,3,0,1] row_mask:0xf bank_mask:0xf
    s_nop 1
    v_add_f32_dpp v14, v14, v14 row_half_mirror row_mask:0xf bank_mask:0xf
    v_mov_b32 v15, 0x3727c5ac
    v_fmac_f32 v15, 0x3b2aaaab, v14
    v_rsq_f32 v14, v15
    s_nop 0
    v_mov_b32 v15, v14
    v_pk_mul_f32 v[48:49], v[48:49], v[14:15]
    v_cvt_pk_bf16_f32 v24, v48, v49
    v_pk_mul_f32 v[50:51], v[50:51], v[14:15]
    v_cvt_pk_bf16_f32 v25, v50, v51
    v_pk_mul_f32 v[52:53], v[52:53], v[14:15]
    v_cvt_pk_bf16_f32 v26, v52, v53
    v_pk_mul_f32 v[54:55], v[54:55], v[14:15]
    v_cvt_pk_bf16_f32 v27, v54, v55
    ds_write_b128 v7, v[24:27] offset:0
    v_pk_mul_f32 v[56:57], v[56:57], v[14:15]
    v_cvt_pk_bf16_f32 v28, v56, v57
    v_pk_mul_f32 v[58:59], v[58:59], v[14:15]
    v_cvt_pk_bf16_f32 v29, v58, v59
    v_pk_mul_f32 v[60:61], v[60:61], v[14:15]
    v_cvt_pk_bf16_f32 v30, v60, v61
    v_pk_mul_f32 v[62:63], v[62:63], v[14:15]
    v_cvt_pk_bf16_f32 v31, v62, v63
    ds_write_b128 v7, v[28:31] offset:2048
    v_pk_mul_f32 v[64:65], v[64:65], v[14:15]
    v_cvt_pk_bf16_f32 v32, v64, v65
    v_pk_mul_f32 v[66:67], v[66:67], v[14:15]
    v_cvt_pk_bf16_f32 v33, v66, v67
    v_pk_mul_f32 v[68:69], v[68:69], v[14:15]
    v_cvt_pk_bf16_f32 v34, v68, v69
    v_pk_mul_f32 v[70:71], v[70:71], v[14:15]
    v_cvt_pk_bf16_f32 v35, v70, v71
    ds_write_b128 v7, v[32:35] offset:4096
    v_pk_mul_f32 v[72:73], v[72:73], v[14:15]
    v_cvt_pk_bf16_f32 v36, v72, v73
    v_pk_mul_f32 v[74:75], v[74:75], v[14:15]
    v_cvt_pk_bf16_f32 v37, v74, v75
    v_pk_mul_f32 v[76:77], v[76:77], v[14:15]
    v_cvt_pk_bf16_f32 v38, v76, v77
    v_pk_mul_f32 v[78:79], v[78:79], v[14:15]
    v_cvt_pk_bf16_f32 v39, v78, v79
    ds_write_b128 v7, v[36:39] offset:6144
    v_pk_mul_f32 v[80:81], v[80:81], v[14:15]
    v_cvt_pk_bf16_f32 v40, v80, v81
    v_pk_mul_f32 v[82:83], v[82:83], v[14:15]
    v_cvt_pk_bf16_f32 v41, v82, v83
    v_pk_mul_f32 v[84:85], v[84:85], v[14:15]
    v_cvt_pk_bf16_f32 v42, v84, v85
    v_pk_mul_f32 v[86:87], v[86:87], v[14:15]
    v_cvt_pk_bf16_f32 v43, v86, v87
    ds_write_b128 v7, v[40:43] offset:8192
pad28:
    s_cbranch_execz wretA
    v_pk_mul_f32 v[88:89], v[88:89], v[14:15]
    v_cvt_pk_bf16_f32 v44, v88, v89
    v_pk_mul_f32 v[90:91], v[90:91], v[14:15]
    v_cvt_pk_bf16_f32 v45, v90, v91
    v_pk_mul_f32 v[92:93], v[92:93], v[14:15]
    v_cvt_pk_bf16_f32 v46, v92, v93
    v_pk_mul_f32 v[94:95], v[94:95], v[14:15]
    v_cvt_pk_bf16_f32 v47, v94, v95
    ds_write_b128 v7, v[44:47] offset:10240
    s_waitcnt lgkmcnt(0)
    s_barrier
p1_h3:
    s_lshr_b32 s42, s2, 3
    s_mov_b64 exec, 0
    s_cmp_eq_u32 s42, 0
    s_cbranch_scc1 pad32
    s_cmp_eq_u32 s42, 1
    s_cbranch_scc1 pad33
    s_cmp_eq_u32 s42, 2
    s_cbranch_scc1 pad34
    s_cmp_eq_u32 s42, 3
    s_cbranch_scc1 pad35
    s_cmp_eq_u32 s42, 4
    s_cbranch_scc1 pad36
    s_cmp_eq_u32 s42, 5
    s_cbranch_scc1 pad37
    s_cmp_eq_u32 s42, 6
    s_cbranch_scc1 pad38
    s_cmp_eq_u32 s42, 7
    s_cbranch_scc1 pad39
    s_cmp_eq_u32 s42, 8
    s_cbranch_scc1 pad40
    s_cmp_eq_u32 s42, 9
    s_cbranch_scc1 pad41
    s_cmp_eq_u32 s42, 10
    s_cbranch_scc1 pad42
    s_cmp_eq_u32 s42, 11
    s_cbranch_scc1 pad43
    s_cmp_eq_u32 s42, 12
    s_cbranch_scc1 pad44
    s_cmp_eq_u32 s42, 13
    s_cbranch_scc1 pad45
    s_cmp_eq_u32 s42, 14
    s_cbranch_scc1 pad46
    s_cmp_eq_u32 s42, 15
    s_cbranch_scc1 pad47
    s_cmp_eq_u32 s42, 16
    s_cbranch_scc1 pad48
    s_cmp_eq_u32 s42, 17
    s_cbranch_scc1 pad49
    s_cmp_eq_u32 s42, 18
    s_cbranch_scc1 pad50
    s_cmp_eq_u32 s42, 19
    s_cbranch_scc1 pad51
    s_cmp_eq_u32 s42, 20
    s_cbranch_scc1 pad52
    s_cmp_eq_u32 s42, 21
    s_cbranch_scc1 pad53
    s_cmp_eq_u32 s42, 22
    s_cbranch_scc1 pad54
    s_cmp_eq_u32 s42, 23
    s_cbranch_scc1 pad55
    s_cmp_eq_u32 s42, 24
    s_cbranch_scc1 pad56
    s_cmp_eq_u32 s42, 25
    s_cbranch_scc1 pad57
    s_cmp_eq_u32 s42, 26
    s_cbranch_scc1 pad58
    s_cmp_eq_u32 s42, 27
    s_cbranch_scc1 pad59
    s_cmp_eq_u32 s42, 28
    s_cbranch_scc1 pad60
    s_cmp_eq_u32 s42, 29
    s_cbranch_scc1 pad61
    s_cmp_eq_u32 s42, 30
    s_cbranch_scc1 pad62
    s_cmp_eq_u32 s42, 31
    s_cbranch_scc1 pad63
wretB:
    s_mov_b64 exec, -1
    s_cmp_lg_u32 s3, 3
    s_cbranch_scc1 kb_w2163_d
    s_mov_b32 s42, s55
    v_lshrrev_b32 v7, 3, v0
    v_lshlrev_b32 v7, 7, v7
    v_and_b32 v6, 7, v0
    v_lshl_add_u32 v7, v6, 2, v7
    s_mov_b32 s43, 0x40000
    s_mov_b32 exec_lo, 0x1
    s_mov_b32 exec_hi, 0x0
kb_w2163:
    buffer_load_dword v6, v5, s[8:11], s42 offen sc1
    s_sub_u32 s43, s43, 1
    s_cbranch_scc1 kb_w2163_x
    s_waitcnt vmcnt(0)
    v_cmp_ne_u32 vcc, 1, v6
    s_cbranch_vccz kb_w2163_x
    s_sleep 24
    s_branch kb_w2163
kb_w2163_x:
    s_mov_b64 exec, -1
kb_w2163_d:
    s_waitcnt lgkmcnt(0)
    s_barrier
    s_cmp_lt_u32 s2, 192
    s_cbranch_scc1 p1_pp
    s_cmp_ge_u32 s36, 60
    s_cbranch_scc1 p1_pp
    s_lshl_b32 s42, s36, 2
    s_add_u32 s42, s42, 17096704
    v_mov_b32 v6, 1
    v_lshlrev_b32 v7, 8, v0
    s_mov_b32 exec_hi, 0
    buffer_store_dword v6, v7, s[20:23], s42 offen sc1
    s_mov_b64 exec, -1
p1_pp:
    v_mov_b32 v88, -1
    v_mov_b32 v89, -1
    v_mov_b32 v90, -1
    v_mov_b32 v91, -1
    s_mul_i32 s32, s3, 12288
    s_sub_u32 s33, s38, s32
    s_sub_u32 s34, s39, s32
    s_lshl_b32 s35, s14, 10
    s_lshl_b32 s36, s13, 3
    s_add_u32 s35, s35, s36
    v_lshlrev_b32 v6, 6, v0
    s_add_u32 s42, s33, 5038080
    buffer_store_dwordx4 v[88:91], v1, s[20:23], s42 offen offset:0 sc1
    s_add_u32 s42, s33, 5050368
    buffer_store_dwordx4 v[88:91], v1, s[20:23], s42 offen offset:0 sc1
    s_add_u32 s42, s33, 5062656
    buffer_store_dwordx4 v[88:91], v1, s[20:23], s42 offen offset:0 sc1
    s_mov_b32 exec_hi, 0xffff
    s_add_u32 s42, s35, 6217728
    buffer_store_dwordx2 v[88:89], v6, s[20:23], s42 offen sc1
    s_mov_b32 exec_hi, 0
    s_add_u32 s42, s34, 5038080
    buffer_store_dwordx4 v[88:91], v1, s[20:23], s42 offen offset:0 sc1
    s_add_u32 s42, s34, 5050368
    buffer_store_dwordx4 v[88:91], v1, s[20:23], s42 offen offset:0 sc1
    s_add_u32 s42, s34, 5062656
    buffer_store_dwordx4 v[88:91], v1, s[20:23], s42 offen offset:0 sc1
    s_mov_b64 exec, -1
    s_lshl_b32 s32, s68, 1
    s_add_u32 s32, s32, s14
    s_lshl_b32 s32, s32, 2
    s_lshr_b32 s33, s13, 1
pad29:
    s_cbranch_execz wretA
    s_add_u32 s32, s32, s33
    s_mul_i32 s32, s32, 3072
    s_add_u32 s42, s32, 9854976
    buffer_store_dwordx4 v[88:91], v1, s[20:23], s42 offen offset:0 sc1
    buffer_store_dwordx4 v[88:91], v1, s[20:23], s42 offen offset:1024 sc1
    buffer_store_dwordx4 v[88:91], v1, s[20:23], s42 offen offset:2048 sc1
    s_cmp_eq_u32 s68, 1
    s_cbranch_scc1 po_4x1
    s_add_u32 s42, s32, 9867264
    buffer_store_dwordx4 v[88:91], v1, s[20:23], s42 offen offset:0 sc1
    buffer_store_dwordx4 v[88:91], v1, s[20:23], s42 offen offset:1024 sc1
    buffer_store_dwordx4 v[88:91], v1, s[20:23], s42 offen offset:2048 sc1
po_4x1:
p1_poll:
    s_cmp_lg_u32 s3, 3
    s_cbranch_scc1 kb_w2245_d
    s_lshl_b32 s42, s12, 8
    s_add_u32 s42, s42, 17096704
    v_lshrrev_b32 v7, 3, v0
    v_lshlrev_b32 v7, 7, v7
    v_and_b32 v6, 7, v0
    v_lshl_add_u32 v7, v6, 2, v7
    s_mov_b32 s43, 0x40000
    s_mov_b32 exec_lo, 0x3f
    s_mov_b32 exec_hi, 0x0
kb_w2245:
    buffer_load_dword v6, v5, s[20:23], s42 offen sc1
    s_sub_u32 s43, s43, 1
    s_cbranch_scc1 kb_w2245_x
    s_waitcnt vmcnt(0)
    v_cmp_ne_u32 vcc, 1, v6
    s_cbranch_vccz kb_w2245_x
    s_sleep 2
    s_branch kb_w2245
kb_w2245_x:
    s_mov_b64 exec, -1
kb_w2245_d:
    v_mov_b32 v6, 1
    ds_write_b32 v18, v6
    s_branch p2_pre
p1_helper:
    s_cmp_lg_u32 s2, 255
    s_cbranch_scc1 p1_nz
    v_mov_b32 v25, 0
    v_mov_b32 v26, 0
    v_mov_b32 v27, 0
    s_mul_i32 s47, s3, 18432
    s_add_u32 s42, s47, 17031168
    buffer_store_dwordx4 v[24:27], v1, s[20:23], s42 offen sc1
    s_add_u32 s42, s47, 17032192
    buffer_store_dwordx4 v[24:27], v1, s[20:23], s42 offen sc1
    s_add_u32 s42, s47, 17033216
    buffer_store_dwordx4 v[24:27], v1, s[20:23], s42 offen sc1
    s_add_u32 s42, s47, 17034240
    buffer_store_dwordx4 v[24:27], v1, s[20:23], s42 offen sc1
    s_add_u32 s42, s47, 17035264
    buffer_store_dwordx4 v[24:27], v1, s[20:23], s42 offen sc1
    s_add_u32 s42, s47, 17036288
    buffer_store_dwordx4 v[24:27], v1, s[20:23], s42 offen sc1
    s_add_u32 s42, s47, 17037312
    buffer_store_dwordx4 v[24:27], v1, s[20:23], s42 offen sc1
    s_add_u32 s42, s47, 17038336
    buffer_store_dwordx4 v[24:27], v1, s[20:23], s42 offen sc1
    s_add_u32 s42, s47, 17039360
    buffer_store_dwordx4 v[24:27], v1, s[20:23], s42 offen sc1
    s_add_u32 s42, s47, 17040384
    buffer_store_dwordx4 v[24:27], v1, s[20:23], s42 offen sc1
    s_add_u32 s42, s47, 17041408
    buffer_store_dwordx4 v[24:27], v1, s[20:23], s42 offen sc1
    s_add_u32 s42, s47, 17042432
    buffer_store_dwordx4 v[24:27], v1, s[20:23], s42 offen sc1
    s_add_u32 s42, s47, 17043456
    buffer_store_dwordx4 v[24:27], v1, s[20:23], s42 offen sc1
    s_add_u32 s42, s47, 17044480
    buffer_store_dwordx4 v[24:27], v1, s[20:23], s42 offen sc1
    s_add_u32 s42, s47, 17045504
    buffer_store_dwordx4 v[24:27], v1, s[20:23], s42 offen sc1
    s_add_u32 s42, s47, 17046528
pad30:
    s_cbranch_execz wretA
    buffer_store_dwordx4 v[24:27], v1, s[20:23], s42 offen sc1
    s_add_u32 s42, s47, 17047552
    buffer_store_dwordx4 v[24:27], v1, s[20:23], s42 offen sc1
    s_add_u32 s42, s47, 17048576
    buffer_store_dwordx4 v[24:27], v1, s[20:23], s42 offen sc1
    s_waitcnt vmcnt(0)
    s_barrier
    s_cmp_lg_u32 s3, 2
    s_cbranch_scc1 p1_nz
    v_mov_b32 v6, 1
    v_lshlrev_b32 v7, 7, v0
    s_mov_b64 exec, 3
    buffer_store_dword v6, v7, s[8:11], 0 offen sc1
    s_mov_b64 exec, -1
p1_nz:
    s_cmp_eq_u32 s3, 3
    s_cbranch_scc1 p1_w3
    s_cmp_ge_u32 s2, 252
    s_cbranch_scc1 p1_hdone
p1_hw:
    v_bfe_u32 v10, v0, 2, 2
    v_and_b32 v11, 1, v2
    v_lshlrev_b32 v11, 1, v11
    v_and_b32 v8, 3, v0
    v_xor_b32 v11, v11, v8
    v_lshlrev_b32 v11, 4, v11
    v_lshrrev_b32 v6, 2, v0
    v_lshlrev_b32 v6, 6, v6
    v_and_b32 v7, 1, v2
    v_lshl_add_u32 v6, v7, 5, v6
    v_lshl_add_u32 v6, v8, 3, v6
    v_xor_b32 v7, 32, v6
    s_cmp_ge_u32 s36, 24
    s_cbranch_scc1 p1_s3
    s_cmp_eq_u32 s3, 2
    s_cbranch_scc1 p1_hdone
    s_lshl_b32 s36, s36, 1
    s_branch p1_s2
p1_s3:
    s_mul_i32 s36, s36, 3
    s_sub_u32 s36, s36, 24
p1_s2:
    s_add_u32 s36, s36, s3
    s_cmp_ge_u32 s36, 12
    s_cbranch_scc1 p1_c1
    s_mov_b32 s56, s88
    s_and_b32 s57, s89, 0xffff
    s_mov_b32 s58, 0x48000
    s_mov_b32 s59, 0x20000
    s_mov_b32 s37, 768
    s_sub_u32 s47, s36, 0
    s_mov_b32 s48, 0
    s_mov_b32 s49, 4096
    s_mov_b32 s50, 12288
    s_mov_b32 s51, 0
    s_branch p1_hgo
p1_c1:
    s_cmp_ge_u32 s36, 48
    s_cbranch_scc1 p1_c2
    s_mov_b32 s56, s90
    s_and_b32 s57, s91, 0xffff
    s_mov_b32 s58, 0xd8000
    s_mov_b32 s59, 0x20000
    s_mov_b32 s37, 2304
    s_sub_u32 s47, s36, 12
    s_mov_b32 s48, 0
    s_mov_b32 s49, 299008
    s_mov_b32 s50, 12288
    s_mov_b32 s51, 3842048
    s_branch p1_hgo
p1_c2:
    s_cmp_ge_u32 s36, 96
    s_cbranch_scc1 p1_c3
    s_mov_b32 s56, s94
    s_and_b32 s57, s95, 0xffff
    s_mov_b32 s58, 0x120000
    s_mov_b32 s59, 0x20000
    s_mov_b32 s37, 3072
    s_sub_u32 s47, s36, 48
    s_mov_b32 s48, 0
pad31:
    s_cbranch_execz wretA
    s_mov_b32 s49, 1478656
    s_mov_b32 s50, 12288
    s_mov_b32 s51, 3850240
    s_branch p1_hgo
p1_c3:
    s_cmp_ge_u32 s36, 108
    s_cbranch_scc1 p1_c4
    s_mov_b32 s56, s92
    s_and_b32 s57, s93, 0xffff
    s_mov_b32 s58, 0x48000
    s_mov_b32 s59, 0x20000
    s_mov_b32 s37, 768
    s_sub_u32 s47, s36, 96
    s_mov_b32 s48, 0
    s_mov_b32 s49, 1183744
    s_mov_b32 s50, 12288
    s_mov_b32 s51, 0
    s_branch p1_hgo
p1_c4:
    s_cmp_ge_u32 s36, 120
    s_cbranch_scc1 p1_c5
    s_mov_b32 s56, s96
    s_and_b32 s57, s97, 0xffff
    s_mov_b32 s58, 0x120000
    s_mov_b32 s59, 0x20000
    s_mov_b32 s37, 768
    s_sub_u32 s47, s36, 108
    s_mov_b32 s48, 0
    s_mov_b32 s49, 2662400
    s_mov_b32 s50, 49152
    s_mov_b32 s51, 0
    s_branch p1_hgo
p1_c5:
    s_cmp_ge_u32 s36, 132
    s_cbranch_scc1 p1_c6
    s_mov_b32 s56, s96
    s_and_b32 s57, s97, 0xffff
    s_mov_b32 s58, 0x120000
    s_mov_b32 s59, 0x20000
    s_mov_b32 s37, 768
    s_sub_u32 s47, s36, 120
    s_mov_b32 s48, 294912
    s_mov_b32 s49, 2674688
    s_mov_b32 s50, 49152
    s_mov_b32 s51, 0
    s_branch p1_hgo
p1_c6:
    s_cmp_ge_u32 s36, 144
    s_cbranch_scc1 p1_c7
    s_mov_b32 s56, s96
    s_and_b32 s57, s97, 0xffff
    s_mov_b32 s58, 0x120000
    s_mov_b32 s59, 0x20000
    s_mov_b32 s37, 768
    s_sub_u32 s47, s36, 132
    s_mov_b32 s48, 589824
    s_mov_b32 s49, 2686976
    s_mov_b32 s50, 49152
    s_mov_b32 s51, 0
    s_branch p1_hgo
p1_c7:
    s_mov_b32 s56, s96
    s_and_b32 s57, s97, 0xffff
    s_mov_b32 s58, 0x120000
    s_mov_b32 s59, 0x20000
    s_mov_b32 s37, 768
    s_sub_u32 s47, s36, 144
    s_mov_b32 s48, 884736
    s_mov_b32 s49, 2699264
    s_mov_b32 s50, 49152
    s_mov_b32 s51, 0
p1_hgo:
    v_lshrrev_b32 v12, 2, v0
    v_mul_lo_u32 v12, v12, s37
pad32:
    s_cbranch_execz pad64
    v_lshl_add_u32 v13, v2, 3, v10
    v_mul_lo_u32 v13, v13, s37
    s_lshl_b32 s43, s47, 6
    s_add_u32 s48, s48, s43
    s_lshl_b32 s32, s37, 4
    s_lshl_b32 s33, s37, 2
    s_lshl_b32 s34, s37, 5
    s_mov_b32 s35, s34
    s_mul_i32 s52, s3, 24576
    v_add_u32 v14, s52, v1
    s_cmp_lg_u32 s49, 4096
    s_cbranch_scc1 p1_hnat
    v_mul_u32_u24 v12, 6, v12
    v_mov_b32 v13, v12
    s_mov_b32 s32, 768
    s_mov_b32 s33, 768
    s_mov_b32 s34, 1536
    s_mov_b32 s35, 70656
p1_hnat:
    v_add_u32 v12, v12, v11
    v_add_u32 v13, v13, v11
    s_add_u32 s43, s48, s32
    buffer_load_dwordx4 v[132:135], v12, s[56:59], s48 offen
    s_add_u32 s48, s48, s34
    buffer_load_dwordx4 v[136:139], v12, s[56:59], s43 offen
    s_add_u32 s43, s48, s33
    buffer_load_dwordx4 v[140:143], v13, s[56:59], s48 offen
    s_add_u32 s48, s48, s34
    buffer_load_dwordx4 v[144:147], v13, s[56:59], s43 offen
    s_add_u32 s43, s48, s32
    buffer_load_dwordx4 v[148:151], v12, s[56:59], s48 offen
    s_add_u32 s48, s48, s35
    buffer_load_dwordx4 v[152:155], v12, s[56:59], s43 offen
    s_add_u32 s43, s48, s32
    buffer_load_dwordx4 v[156:159], v12, s[56:59], s48 offen
    s_add_u32 s48, s48, s34
    buffer_load_dwordx4 v[160:163], v12, s[56:59], s43 offen
    s_add_u32 s43, s48, s33
    buffer_load_dwordx4 v[164:167], v13, s[56:59], s48 offen
    s_add_u32 s48, s48, s34
    buffer_load_dwordx4 v[168:171], v13, s[56:59], s43 offen
    s_add_u32 s43, s48, s32
    buffer_load_dwordx4 v[172:175], v12, s[56:59], s48 offen
    s_add_u32 s48, s48, s35
    buffer_load_dwordx4 v[176:179], v12, s[56:59], s43 offen
    s_add_u32 s43, s48, s32
    buffer_load_dwordx4 v[180:183], v12, s[56:59], s48 offen
    s_add_u32 s48, s48, s34
    buffer_load_dwordx4 v[184:187], v12, s[56:59], s43 offen
    s_add_u32 s43, s48, s33
    buffer_load_dwordx4 v[188:191], v13, s[56:59], s48 offen
    s_add_u32 s48, s48, s34
    buffer_load_dwordx4 v[192:195], v13, s[56:59], s43 offen
    s_add_u32 s43, s48, s32
    buffer_load_dwordx4 v[196:199], v12, s[56:59], s48 offen
    s_add_u32 s48, s48, s35
    buffer_load_dwordx4 v[200:203], v12, s[56:59], s43 offen
    s_add_u32 s43, s48, s32
    buffer_load_dwordx4 v[204:207], v12, s[56:59], s48 offen
    s_add_u32 s48, s48, s34
    buffer_load_dwordx4 v[208:211], v12, s[56:59], s43 offen
    s_add_u32 s43, s48, s33
    buffer_load_dwordx4 v[212:215], v13, s[56:59], s48 offen
    s_add_u32 s48, s48, s34
    buffer_load_dwordx4 v[216:219], v13, s[56:59], s43 offen
    s_add_u32 s43, s48, s32
    buffer_load_dwordx4 v[220:223], v12, s[56:59], s48 offen
pad33:
    s_cbranch_execz pad65
    s_add_u32 s48, s48, s35
    buffer_load_dwordx4 v[224:227], v12, s[56:59], s43 offen
    v_add_u32 v6, s52, v6
    v_add_u32 v7, s52, v7
    s_lshl_b32 s53, s47, 1
    s_mul_i32 s53, s53, s50
    s_add_u32 s53, s53, s49
    s_add_u32 s54, s53, s50
    v_mov_b32 v128, 0x3f803f80
    v_mov_b32 v129, 0x3f803f80
    v_mov_b32 v130, 0x3f803f80
    v_mov_b32 v131, 0x3f803f80
    s_waitcnt vmcnt(23)
    ds_write_b128 v14, v[132:135] offset:0
    s_waitcnt vmcnt(22)
    ds_write_b128 v14, v[136:139] offset:1024
    s_waitcnt vmcnt(21)
    ds_write_b128 v14, v[140:143] offset:2048
    s_waitcnt vmcnt(20)
    ds_write_b128 v14, v[144:147] offset:3072
    s_waitcnt vmcnt(19)
    ds_write_b128 v14, v[148:151] offset:4096
    s_waitcnt vmcnt(18)
    ds_write_b128 v14, v[152:155] offset:5120
    s_waitcnt lgkmcnt(0)
    ds_read_b64_tr_b16 v[24:25], v6 offset:0
    ds_read_b64_tr_b16 v[26:27], v6 offset:1024
    ds_read_b64_tr_b16 v[28:29], v7 offset:0
    ds_read_b64_tr_b16 v[30:31], v7 offset:1024
    ds_read_b64_tr_b16 v[32:33], v6 offset:2048
    ds_read_b64_tr_b16 v[34:35], v6 offset:3072
    ds_read_b64_tr_b16 v[36:37], v7 offset:2048
    ds_read_b64_tr_b16 v[38:39], v7 offset:3072
    ds_read_b64_tr_b16 v[40:41], v6 offset:4096
    ds_read_b64_tr_b16 v[42:43], v6 offset:5120
    ds_read_b64_tr_b16 v[44:45], v7 offset:4096
    ds_read_b64_tr_b16 v[46:47], v7 offset:5120
    s_waitcnt lgkmcnt(0)
    buffer_store_dwordx4 v[24:27], v1, s[20:23], s53 offen offset:0 sc1
    v_mfma_f32_16x16x32_bf16 v[120:123], v[24:27], v[128:131], 0
    buffer_store_dwordx4 v[28:31], v1, s[20:23], s54 offen offset:0 sc1
    v_mfma_f32_16x16x32_bf16 v[124:127], v[28:31], v[128:131], 0
    buffer_store_dwordx4 v[32:35], v1, s[20:23], s53 offen offset:1024 sc1
    v_mfma_f32_16x16x32_bf16 v[120:123], v[32:35], v[128:131], v[120:123]
    buffer_store_dwordx4 v[36:39], v1, s[20:23], s54 offen offset:1024 sc1
    v_mfma_f32_16x16x32_bf16 v[124:127], v[36:39], v[128:131], v[124:127]
    buffer_store_dwordx4 v[40:43], v1, s[20:23], s53 offen offset:2048 sc1
    v_mfma_f32_16x16x32_bf16 v[120:123], v[40:43], v[128:131], v[120:123]
    buffer_store_dwordx4 v[44:47], v1, s[20:23], s54 offen offset:2048 sc1
    v_mfma_f32_16x16x32_bf16 v[124:127], v[44:47], v[128:131], v[124:127]
    s_waitcnt vmcnt(23)
    ds_write_b128 v14, v[156:159] offset:6144
    s_waitcnt vmcnt(22)
    ds_write_b128 v14, v[160:163] offset:7168
    s_waitcnt vmcnt(21)
    ds_write_b128 v14, v[164:167] offset:8192
    s_waitcnt vmcnt(20)
    ds_write_b128 v14, v[168:171] offset:9216
    s_waitcnt vmcnt(19)
    ds_write_b128 v14, v[172:175] offset:10240
    s_waitcnt vmcnt(18)
    ds_write_b128 v14, v[176:179] offset:11264
    s_waitcnt lgkmcnt(0)
    ds_read_b64_tr_b16 v[48:49], v6 offset:6144
    ds_read_b64_tr_b16 v[50:51], v6 offset:7168
    ds_read_b64_tr_b16 v[52:53], v7 offset:6144
    ds_read_b64_tr_b16 v[54:55], v7 offset:7168
    ds_read_b64_tr_b16 v[56:57], v6 offset:8192
    ds_read_b64_tr_b16 v[58:59], v6 offset:9216
    ds_read_b64_tr_b16 v[60:61], v7 offset:8192
    ds_read_b64_tr_b16 v[62:63], v7 offset:9216
    ds_read_b64_tr_b16 v[64:65], v6 offset:10240
pad34:
    s_cbranch_execz pad66
    ds_read_b64_tr_b16 v[66:67], v6 offset:11264
    ds_read_b64_tr_b16 v[68:69], v7 offset:10240
    ds_read_b64_tr_b16 v[70:71], v7 offset:11264
    s_waitcnt lgkmcnt(0)
    buffer_store_dwordx4 v[48:51], v1, s[20:23], s53 offen offset:3072 sc1
    v_mfma_f32_16x16x32_bf16 v[120:123], v[48:51], v[128:131], v[120:123]
    buffer_store_dwordx4 v[52:55], v1, s[20:23], s54 offen offset:3072 sc1
    v_mfma_f32_16x16x32_bf16 v[124:127], v[52:55], v[128:131], v[124:127]
    s_add_u32 s53, s53, 4096
    s_add_u32 s54, s54, 4096
    buffer_store_dwordx4 v[56:59], v1, s[20:23], s53 offen offset:0 sc1
    v_mfma_f32_16x16x32_bf16 v[120:123], v[56:59], v[128:131], v[120:123]
    buffer_store_dwordx4 v[60:63], v1, s[20:23], s54 offen offset:0 sc1
    v_mfma_f32_16x16x32_bf16 v[124:127], v[60:63], v[128:131], v[124:127]
    buffer_store_dwordx4 v[64:67], v1, s[20:23], s53 offen offset:1024 sc1
    v_mfma_f32_16x16x32_bf16 v[120:123], v[64:67], v[128:131], v[120:123]
    buffer_store_dwordx4 v[68:71], v1, s[20:23], s54 offen offset:1024 sc1
    v_mfma_f32_16x16x32_bf16 v[124:127], v[68:71], v[128:131], v[124:127]
    s_waitcnt vmcnt(23)
    ds_write_b128 v14, v[180:183] offset:12288
    s_waitcnt vmcnt(22)
    ds_write_b128 v14, v[184:187] offset:13312
    s_waitcnt vmcnt(21)
    ds_write_b128 v14, v[188:191] offset:14336
    s_waitcnt vmcnt(20)
    ds_write_b128 v14, v[192:195] offset:15360
    s_waitcnt vmcnt(19)
    ds_write_b128 v14, v[196:199] offset:16384
    s_waitcnt vmcnt(18)
    ds_write_b128 v14, v[200:203] offset:17408
    s_waitcnt lgkmcnt(0)
    ds_read_b64_tr_b16 v[72:73], v6 offset:12288
    ds_read_b64_tr_b16 v[74:75], v6 offset:13312
    ds_read_b64_tr_b16 v[76:77], v7 offset:12288
    ds_read_b64_tr_b16 v[78:79], v7 offset:13312
    ds_read_b64_tr_b16 v[80:81], v6 offset:14336
    ds_read_b64_tr_b16 v[82:83], v6 offset:15360
    ds_read_b64_tr_b16 v[84:85], v7 offset:14336
    ds_read_b64_tr_b16 v[86:87], v7 offset:15360
    ds_read_b64_tr_b16 v[88:89], v6 offset:16384
    ds_read_b64_tr_b16 v[90:91], v6 offset:17408
    ds_read_b64_tr_b16 v[92:93], v7 offset:16384
    ds_read_b64_tr_b16 v[94:95], v7 offset:17408
    s_waitcnt lgkmcnt(0)
    buffer_store_dwordx4 v[72:75], v1, s[20:23], s53 offen offset:2048 sc1
    v_mfma_f32_16x16x32_bf16 v[120:123], v[72:75], v[128:131], v[120:123]
    buffer_store_dwordx4 v[76:79], v1, s[20:23], s54 offen offset:2048 sc1
    v_mfma_f32_16x16x32_bf16 v[124:127], v[76:79], v[128:131], v[124:127]
    buffer_store_dwordx4 v[80:83], v1, s[20:23], s53 offen offset:3072 sc1
    v_mfma_f32_16x16x32_bf16 v[120:123], v[80:83], v[128:131], v[120:123]
    buffer_store_dwordx4 v[84:87], v1, s[20:23], s54 offen offset:3072 sc1
    v_mfma_f32_16x16x32_bf16 v[124:127], v[84:87], v[128:131], v[124:127]
    s_add_u32 s53, s53, 4096
    s_add_u32 s54, s54, 4096
    buffer_store_dwordx4 v[88:91], v1, s[20:23], s53 offen offset:0 sc1
    v_mfma_f32_16x16x32_bf16 v[120:123], v[88:91], v[128:131], v[120:123]
    buffer_store_dwordx4 v[92:95], v1, s[20:23], s54 offen offset:0 sc1
    v_mfma_f32_16x16x32_bf16 v[124:127], v[92:95], v[128:131], v[124:127]
    s_waitcnt vmcnt(23)
    ds_write_b128 v14, v[204:207] offset:18432
    s_waitcnt vmcnt(22)
    ds_write_b128 v14, v[208:211] offset:19456
    s_waitcnt vmcnt(21)
    ds_write_b128 v14, v[212:215] offset:20480
    s_waitcnt vmcnt(20)
    ds_write_b128 v14, v[216:219] offset:21504
    s_waitcnt vmcnt(19)
    ds_write_b128 v14, v[220:223] offset:22528
    s_waitcnt vmcnt(18)
    ds_write_b128 v14, v[224:227] offset:23552
    s_waitcnt lgkmcnt(0)
    ds_read_b64_tr_b16 v[96:97], v6 offset:18432
pad35:
    s_cbranch_execz pad67
    ds_read_b64_tr_b16 v[98:99], v6 offset:19456
    ds_read_b64_tr_b16 v[100:101], v7 offset:18432
    ds_read_b64_tr_b16 v[102:103], v7 offset:19456
    ds_read_b64_tr_b16 v[104:105], v6 offset:20480
    ds_read_b64_tr_b16 v[106:107], v6 offset:21504
    ds_read_b64_tr_b16 v[108:109], v7 offset:20480
    ds_read_b64_tr_b16 v[110:111], v7 offset:21504
    ds_read_b64_tr_b16 v[112:113], v6 offset:22528
    ds_read_b64_tr_b16 v[114:115], v6 offset:23552
    ds_read_b64_tr_b16 v[116:117], v7 offset:22528
    ds_read_b64_tr_b16 v[118:119], v7 offset:23552
    s_waitcnt lgkmcnt(0)
    buffer_store_dwordx4 v[96:99], v1, s[20:23], s53 offen offset:1024 sc1
    v_mfma_f32_16x16x32_bf16 v[120:123], v[96:99], v[128:131], v[120:123]
    buffer_store_dwordx4 v[100:103], v1, s[20:23], s54 offen offset:1024 sc1
    v_mfma_f32_16x16x32_bf16 v[124:127], v[100:103], v[128:131], v[124:127]
    buffer_store_dwordx4 v[104:107], v1, s[20:23], s53 offen offset:2048 sc1
    v_mfma_f32_16x16x32_bf16 v[120:123], v[104:107], v[128:131], v[120:123]
    buffer_store_dwordx4 v[108:111], v1, s[20:23], s54 offen offset:2048 sc1
    v_mfma_f32_16x16x32_bf16 v[124:127], v[108:111], v[128:131], v[124:127]
    buffer_store_dwordx4 v[112:115], v1, s[20:23], s53 offen offset:3072 sc1
    v_mfma_f32_16x16x32_bf16 v[120:123], v[112:115], v[128:131], v[120:123]
    buffer_store_dwordx4 v[116:119], v1, s[20:23], s54 offen offset:3072 sc1
    v_mfma_f32_16x16x32_bf16 v[124:127], v[116:119], v[128:131], v[124:127]
    s_add_u32 s53, s53, 4096
    s_add_u32 s54, s54, 4096
    s_cmp_eq_u32 s51, 0
    s_cbranch_scc1 p1_hdone
    s_lshl_b32 s43, s47, 7
    s_add_u32 s51, s51, s43
    v_lshlrev_b32 v10, 4, v2
    v_cmp_eq_u32 vcc, 0, v3
    s_nop 7
    s_mov_b64 exec, vcc
    buffer_store_dwordx4 v[120:123], v10, s[20:23], s51 offen offset:0 sc1
    buffer_store_dwordx4 v[124:127], v10, s[20:23], s51 offen offset:64 sc1
    s_mov_b64 exec, -1
p1_hdone:
    s_waitcnt vmcnt(0) lgkmcnt(0)
    s_barrier
    s_branch p1_spin
p2_pre:
    buffer_load_dwordx2 v[16:17], v4, s[24:27], s74 offen
    buffer_load_dwordx2 v[18:19], v4, s[24:27], s75 offen
    buffer_load_dwordx2 v[20:21], v4, s[24:27], s76 offen
    s_add_u32 s42, s77, 4096
    buffer_load_dwordx4 v[188:191], v1, s[20:23], s42 offen offset:0
    buffer_load_dwordx4 v[192:195], v1, s[20:23], s42 offen offset:1024
    buffer_load_dwordx4 v[196:199], v1, s[20:23], s42 offen offset:2048
    s_add_u32 s42, s78, 4096
    buffer_load_dwordx4 v[200:203], v1, s[20:23], s42 offen offset:0
    buffer_load_dwordx4 v[204:207], v1, s[20:23], s42 offen offset:1024
    buffer_load_dwordx4 v[208:211], v1, s[20:23], s42 offen offset:2048
    s_add_u32 s42, s79, 4096
    buffer_load_dwordx4 v[212:215], v1, s[20:23], s42 offen offset:0
    buffer_load_dwordx4 v[216:219], v1, s[20:23], s42 offen offset:1024
    buffer_load_dwordx4 v[220:223], v1, s[20:23], s42 offen offset:2048
    s_cmp_lg_u32 s3, 3
    s_cbranch_scc1 w2_d
    s_lshl_b32 s42, s12, 9
    s_add_u32 s42, s42, 17047552
    s_lshl_b32 s47, s12, 8
    s_add_u32 s47, s47, 17096704
    s_mov_b32 s43, 0x40000
    v_lshrrev_b32 v7, 3, v0
    v_lshlrev_b32 v7, 7, v7
    v_and_b32 v6, 7, v0
    v_lshl_add_u32 v7, v6, 2, v7
    v_mov_b32 v6, 1
w2_l:
    s_mov_b64 exec, 0xffffff
    buffer_load_dword v6, v7, s[20:23], s42 offen sc1
    s_mov_b32 exec_lo, -1
pad36:
    s_cbranch_execz pad68
    s_mov_b32 exec_hi, 0xfffffff
    buffer_load_dword v8, v5, s[20:23], s47 offen sc1
    s_sub_u32 s43, s43, 1
    s_cbranch_scc1 w2_x
    s_waitcnt vmcnt(0)
    v_and_b32 v8, v8, v6
    v_cmp_ne_u32 vcc, 1, v8
    s_cbranch_vccnz w2_l
w2_x:
    s_mov_b64 exec, -1
w2_d:
    s_barrier
    s_add_u32 s32, s16, 3858432
    s_add_u32 s33, s16, 3870720
    s_add_u32 s34, s16, 3883008
    buffer_load_dwordx4 v[60:63], v1, s[20:23], s32 offen offset:0 sc1
    buffer_load_dwordx4 v[64:67], v1, s[20:23], s33 offen offset:0 sc1
    buffer_load_dwordx4 v[68:71], v1, s[20:23], s34 offen offset:0 sc1
    buffer_load_dwordx4 v[72:75], v1, s[20:23], s32 offen offset:1024 sc1
    buffer_load_dwordx4 v[76:79], v1, s[20:23], s33 offen offset:1024 sc1
    buffer_load_dwordx4 v[80:83], v1, s[20:23], s34 offen offset:1024 sc1
    buffer_load_dwordx4 v[84:87], v1, s[20:23], s32 offen offset:2048 sc1
    buffer_load_dwordx4 v[88:91], v1, s[20:23], s33 offen offset:2048 sc1
    buffer_load_dwordx4 v[92:95], v1, s[20:23], s34 offen offset:2048 sc1
    v_lshlrev_b32 v8, 2, v9
    s_mul_i32 s43, s13, 768
    s_add_u32 s42, s43, 3842048
    buffer_load_dword v10, v8, s[20:23], s42 offen
    s_add_u32 s42, s43, 3850240
    buffer_load_dword v14, v8, s[20:23], s42 offen
    s_add_u32 s42, s80, 299008
    buffer_load_dwordx4 a[0:3], v1, s[20:23], s42 offen offset:0
    buffer_load_dwordx4 a[4:7], v1, s[20:23], s42 offen offset:1024
    buffer_load_dwordx4 a[8:11], v1, s[20:23], s42 offen offset:2048
    buffer_load_dwordx4 a[12:15], v1, s[20:23], s42 offen offset:3072
    s_add_u32 s42, s80, 303104
    buffer_load_dwordx4 a[16:19], v1, s[20:23], s42 offen offset:0
    buffer_load_dwordx4 a[20:23], v1, s[20:23], s42 offen offset:1024
    buffer_load_dwordx4 a[24:27], v1, s[20:23], s42 offen offset:2048
    buffer_load_dwordx4 a[28:31], v1, s[20:23], s42 offen offset:3072
    s_add_u32 s42, s80, 307200
    buffer_load_dwordx4 a[32:35], v1, s[20:23], s42 offen offset:0
    buffer_load_dwordx4 a[36:39], v1, s[20:23], s42 offen offset:1024
    buffer_load_dwordx4 a[40:43], v1, s[20:23], s42 offen offset:2048
    buffer_load_dwordx4 a[44:47], v1, s[20:23], s42 offen offset:3072
    v_mov_b32 v11, 1.0
    v_mov_b32 v15, 1.0
    v_lshlrev_b32 v8, 3, v9
    v_add_u32 v8, 74112, v8
    s_waitcnt vmcnt(20)
    v_mfma_f32_16x16x32_bf16 v[24:27], v[188:191], v[60:63], 0
    v_mfma_f32_16x16x32_bf16 v[28:31], v[200:203], v[60:63], 0
    v_mfma_f32_16x16x32_bf16 v[32:35], v[212:215], v[60:63], 0
    v_mfma_f32_16x16x32_bf16 v[36:39], v[188:191], v[64:67], 0
    v_mfma_f32_16x16x32_bf16 v[40:43], v[200:203], v[64:67], 0
    v_mfma_f32_16x16x32_bf16 v[44:47], v[212:215], v[64:67], 0
    v_mfma_f32_16x16x32_bf16 v[48:51], v[188:191], v[68:71], 0
    v_mfma_f32_16x16x32_bf16 v[52:55], v[200:203], v[68:71], 0
    v_mfma_f32_16x16x32_bf16 v[56:59], v[212:215], v[68:71], 0
    s_waitcnt vmcnt(17)
    v_mfma_f32_16x16x32_bf16 v[24:27], v[192:195], v[72:75], v[24:27]
    v_mfma_f32_16x16x32_bf16 v[28:31], v[204:207], v[72:75], v[28:31]
    v_mfma_f32_16x16x32_bf16 v[32:35], v[216:219], v[72:75], v[32:35]
    v_mfma_f32_16x16x32_bf16 v[36:39], v[192:195], v[76:79], v[36:39]
    v_mfma_f32_16x16x32_bf16 v[40:43], v[204:207], v[76:79], v[40:43]
    v_mfma_f32_16x16x32_bf16 v[44:47], v[216:219], v[76:79], v[44:47]
    v_mfma_f32_16x16x32_bf16 v[48:51], v[192:195], v[80:83], v[48:51]
    v_mfma_f32_16x16x32_bf16 v[52:55], v[204:207], v[80:83], v[52:55]
    v_mfma_f32_16x16x32_bf16 v[56:59], v[216:219], v[80:83], v[56:59]
    s_waitcnt vmcnt(14)
    v_mfma_f32_16x16x32_bf16 v[24:27], v[196:199], v[84:87], v[24:27]
    v_mfma_f32_16x16x32_bf16 v[28:31], v[208:211], v[84:87], v[28:31]
    v_mfma_f32_16x16x32_bf16 v[32:35], v[220:223], v[84:87], v[32:35]
pad37:
    s_cbranch_execz pad69
    v_mfma_f32_16x16x32_bf16 v[36:39], v[196:199], v[88:91], v[36:39]
    v_mfma_f32_16x16x32_bf16 v[40:43], v[208:211], v[88:91], v[40:43]
    v_mfma_f32_16x16x32_bf16 v[44:47], v[220:223], v[88:91], v[44:47]
    v_mfma_f32_16x16x32_bf16 v[48:51], v[196:199], v[92:95], v[48:51]
    v_mfma_f32_16x16x32_bf16 v[52:55], v[208:211], v[92:95], v[52:55]
    v_mfma_f32_16x16x32_bf16 v[56:59], v[220:223], v[92:95], v[56:59]
    s_cmp_eq_u32 s3, 3
    s_cbranch_scc1 on2826
    s_waitcnt vmcnt(12)
    ds_write_b64 v8, v[10:11]
    ds_write_b64 v8, v[14:15] offset:2048
on2826:
    s_add_u32 s42, s81, 299008
    buffer_load_dwordx4 a[48:51], v1, s[20:23], s42 offen offset:0
    buffer_load_dwordx4 a[52:55], v1, s[20:23], s42 offen offset:1024
    buffer_load_dwordx4 a[56:59], v1, s[20:23], s42 offen offset:2048
    buffer_load_dwordx4 a[60:63], v1, s[20:23], s42 offen offset:3072
    s_add_u32 s42, s81, 303104
    buffer_load_dwordx4 a[64:67], v1, s[20:23], s42 offen offset:0
    buffer_load_dwordx4 a[68:71], v1, s[20:23], s42 offen offset:1024
    buffer_load_dwordx4 a[72:75], v1, s[20:23], s42 offen offset:2048
    buffer_load_dwordx4 a[76:79], v1, s[20:23], s42 offen offset:3072
    s_add_u32 s42, s81, 307200
    buffer_load_dwordx4 a[80:83], v1, s[20:23], s42 offen offset:0
    buffer_load_dwordx4 a[84:87], v1, s[20:23], s42 offen offset:1024
    buffer_load_dwordx4 a[88:91], v1, s[20:23], s42 offen offset:2048
    buffer_load_dwordx4 a[92:95], v1, s[20:23], s42 offen offset:3072
    s_mul_i32 s42, s3, 9216
    s_add_u32 s42, s42, 36864
    v_add_u32 v6, s42, v1
    s_mul_i32 s42, s3, 3072
    s_add_u32 s42, s42, 36864
    v_add_u32 v7, s42, v1
    s_nop 2
    ds_write_b128 v6, v[24:27] offset:0
    ds_write_b128 v6, v[28:31] offset:1024
    ds_write_b128 v6, v[32:35] offset:2048
    ds_write_b128 v6, v[36:39] offset:3072
    ds_write_b128 v6, v[40:43] offset:4096
    ds_write_b128 v6, v[44:47] offset:5120
    ds_write_b128 v6, v[48:51] offset:6144
    ds_write_b128 v6, v[52:55] offset:7168
    ds_write_b128 v6, v[56:59] offset:8192
    s_waitcnt lgkmcnt(0)
    s_barrier
    s_cmp_eq_u32 s3, 3
    s_cbranch_scc1 p2_fin
    ds_read_b128 v[60:63], v7 offset:0
    ds_read_b128 v[64:67], v7 offset:1024
    ds_read_b128 v[68:71], v7 offset:2048
    ds_read_b128 v[72:75], v7 offset:9216
    ds_read_b128 v[76:79], v7 offset:10240
    ds_read_b128 v[80:83], v7 offset:11264
    ds_read_b128 v[84:87], v7 offset:18432
    ds_read_b128 v[88:91], v7 offset:19456
    ds_read_b128 v[92:95], v7 offset:20480
    ds_read_b128 v[96:99], v7 offset:27648
    ds_read_b128 v[100:103], v7 offset:28672
    ds_read_b128 v[104:107], v7 offset:29696
    v_lshlrev_b32 v24, 16, v16
    v_and_b32 v25, 0xffff0000, v16
    v_lshlrev_b32 v26, 16, v17
    v_and_b32 v27, 0xffff0000, v17
    v_lshlrev_b32 v28, 16, v18
    v_and_b32 v29, 0xffff0000, v18
    v_lshlrev_b32 v30, 16, v19
    v_and_b32 v31, 0xffff0000, v19
    v_lshlrev_b32 v32, 16, v20
    v_and_b32 v33, 0xffff0000, v20
    v_lshlrev_b32 v34, 16, v21
    v_and_b32 v35, 0xffff0000, v21
    s_waitcnt lgkmcnt(9)
pad38:
    s_cbranch_execz pad70
    v_pk_add_f32 v[24:25], v[24:25], v[60:61]
    v_pk_add_f32 v[26:27], v[26:27], v[62:63]
    v_pk_add_f32 v[28:29], v[28:29], v[64:65]
    v_pk_add_f32 v[30:31], v[30:31], v[66:67]
    v_pk_add_f32 v[32:33], v[32:33], v[68:69]
    v_pk_add_f32 v[34:35], v[34:35], v[70:71]
    s_waitcnt lgkmcnt(6)
    v_pk_add_f32 v[24:25], v[24:25], v[72:73]
    v_pk_add_f32 v[26:27], v[26:27], v[74:75]
    v_pk_add_f32 v[28:29], v[28:29], v[76:77]
    v_pk_add_f32 v[30:31], v[30:31], v[78:79]
    v_pk_add_f32 v[32:33], v[32:33], v[80:81]
    v_pk_add_f32 v[34:35], v[34:35], v[82:83]
    s_waitcnt lgkmcnt(3)
    v_pk_add_f32 v[24:25], v[24:25], v[84:85]
    v_pk_add_f32 v[26:27], v[26:27], v[86:87]
    v_pk_add_f32 v[28:29], v[28:29], v[88:89]
    v_pk_add_f32 v[30:31], v[30:31], v[90:91]
    v_pk_add_f32 v[32:33], v[32:33], v[92:93]
    v_pk_add_f32 v[34:35], v[34:35], v[94:95]
    s_waitcnt lgkmcnt(0)
    v_pk_add_f32 v[24:25], v[24:25], v[96:97]
    v_pk_add_f32 v[26:27], v[26:27], v[98:99]
    v_pk_add_f32 v[28:29], v[28:29], v[100:101]
    v_pk_add_f32 v[30:31], v[30:31], v[102:103]
    v_pk_add_f32 v[32:33], v[32:33], v[104:105]
    v_pk_add_f32 v[34:35], v[34:35], v[106:107]
    v_cvt_pk_bf16_f32 v16, v24, v25
    v_cvt_pk_bf16_f32 v17, v26, v27
    v_cvt_pk_bf16_f32 v18, v28, v29
    v_cvt_pk_bf16_f32 v19, v30, v31
    v_cvt_pk_bf16_f32 v20, v32, v33
    v_cvt_pk_bf16_f32 v21, v34, v35
    s_add_u32 s42, s38, 5038080
    buffer_store_dwordx4 v[16:19], v1, s[20:23], s42 offen sc1
    v_mov_b32 v12, v20
    v_mov_b32 v13, v21
    s_add_u32 s42, s39, 5038080
    v_mov_b32 v14, v12
    v_mov_b32 v15, v13
    s_nop 1
    v_permlane16_swap_b32 v12, v14
    v_permlane16_swap_b32 v13, v15
    s_mov_b64 exec, s[72:73]
    buffer_store_dwordx4 v[12:15], v23, s[20:23], s42 offen sc1
    s_mov_b64 exec, -1
    v_lshlrev_b32 v24, 16, v16
    v_and_b32 v25, 0xffff0000, v16
    v_lshlrev_b32 v26, 16, v17
    v_and_b32 v27, 0xffff0000, v17
    v_lshlrev_b32 v28, 16, v18
    v_and_b32 v29, 0xffff0000, v18
    v_lshlrev_b32 v30, 16, v19
    v_and_b32 v31, 0xffff0000, v19
    v_lshlrev_b32 v32, 16, v20
    v_and_b32 v33, 0xffff0000, v20
    v_lshlrev_b32 v34, 16, v21
    v_and_b32 v35, 0xffff0000, v21
    v_pk_add_f32 v[60:61], v[24:25], v[26:27]
    v_pk_mul_f32 v[62:63], v[24:25], v[24:25]
    v_pk_add_f32 v[60:61], v[60:61], v[28:29]
    v_pk_add_f32 v[60:61], v[60:61], v[30:31]
    v_pk_add_f32 v[60:61], v[60:61], v[32:33]
    v_pk_add_f32 v[60:61], v[60:61], v[34:35]
    v_pk_fma_f32 v[62:63], v[26:27], v[26:27], v[62:63]
    v_pk_fma_f32 v[62:63], v[28:29], v[28:29], v[62:63]
    v_pk_fma_f32 v[62:63], v[30:31], v[30:31], v[62:63]
    v_pk_fma_f32 v[62:63], v[32:33], v[32:33], v[62:63]
    v_pk_fma_f32 v[62:63], v[34:35], v[34:35], v[62:63]
    v_add_f32 v60, v60, v61
    v_add_f32 v61, v62, v63
    v_mov_b32 v64, v60
    s_nop 1
pad39:
    s_cbranch_execz pad71
    v_permlane16_swap_b32 v60, v64
    s_nop 1
    v_add_f32 v60, v60, v64
    v_mov_b32 v64, v60
    s_nop 1
    v_permlane32_swap_b32 v60, v64
    s_nop 1
    v_add_f32 v60, v60, v64
    v_mov_b32 v64, v61
    s_nop 1
    v_permlane16_swap_b32 v61, v64
    s_nop 1
    v_add_f32 v61, v61, v64
    v_mov_b32 v64, v61
    s_nop 1
    v_permlane32_swap_b32 v61, v64
    s_nop 1
    v_add_f32 v61, v61, v64
    v_lshlrev_b32 v6, 6, v0
    s_lshl_b32 s42, s19, 10
    s_lshl_b32 s43, s13, 3
    s_add_u32 s42, s42, s43
    s_add_u32 s42, s42, 6217728
    s_mov_b64 exec, 0xffff
    buffer_store_dwordx2 v[60:61], v6, s[20:23], s42 offen sc1
    s_mov_b64 exec, -1
p2_fin:
    s_cmp_lg_u32 s3, 3
    s_cbranch_scc1 on2992
    s_add_u32 s42, s82, 299008
    buffer_load_dwordx4 a[96:99], v1, s[20:23], s42 offen offset:0
    buffer_load_dwordx4 a[100:103], v1, s[20:23], s42 offen offset:1024
    buffer_load_dwordx4 a[104:107], v1, s[20:23], s42 offen offset:2048
    buffer_load_dwordx4 a[108:111], v1, s[20:23], s42 offen offset:3072
    s_add_u32 s42, s82, 303104
    buffer_load_dwordx4 a[112:115], v1, s[20:23], s42 offen offset:0
    buffer_load_dwordx4 a[116:119], v1, s[20:23], s42 offen offset:1024
    buffer_load_dwordx4 a[120:123], v1, s[20:23], s42 offen offset:2048
    buffer_load_dwordx4 a[124:127], v1, s[20:23], s42 offen offset:3072
    s_add_u32 s42, s82, 307200
    buffer_load_dwordx4 a[128:131], v1, s[20:23], s42 offen offset:0
    buffer_load_dwordx4 a[132:135], v1, s[20:23], s42 offen offset:1024
    buffer_load_dwordx4 a[136:139], v1, s[20:23], s42 offen offset:2048
    buffer_load_dwordx4 a[140:143], v1, s[20:23], s42 offen offset:3072
on2992:
    s_barrier
    s_cmp_lg_u32 s3, 0
    s_cbranch_scc1 kb_s0_3011
    s_mov_b32 s42, s46
    s_mov_b64 exec, 1
    v_mov_b32 v6, 1
    v_lshlrev_b32 v7, 8, v0
    buffer_store_dword v6, v7, s[20:23], s42 offen sc1
    s_mov_b64 exec, -1
kb_s0_3011:
    s_cmp_eq_u32 s3, 3
    s_cbranch_scc1 on3020
    s_add_u32 s42, s82, 299008
    buffer_load_dwordx4 a[96:99], v1, s[20:23], s42 offen offset:0
    buffer_load_dwordx4 a[100:103], v1, s[20:23], s42 offen offset:1024
    buffer_load_dwordx4 a[104:107], v1, s[20:23], s42 offen offset:2048
    buffer_load_dwordx4 a[108:111], v1, s[20:23], s42 offen offset:3072
    s_add_u32 s42, s82, 303104
    buffer_load_dwordx4 a[112:115], v1, s[20:23], s42 offen offset:0
    buffer_load_dwordx4 a[116:119], v1, s[20:23], s42 offen offset:1024
    buffer_load_dwordx4 a[120:123], v1, s[20:23], s42 offen offset:2048
    buffer_load_dwordx4 a[124:127], v1, s[20:23], s42 offen offset:3072
    s_add_u32 s42, s82, 307200
    buffer_load_dwordx4 a[128:131], v1, s[20:23], s42 offen offset:0
    buffer_load_dwordx4 a[132:135], v1, s[20:23], s42 offen offset:1024
    buffer_load_dwordx4 a[136:139], v1, s[20:23], s42 offen offset:2048
    buffer_load_dwordx4 a[140:143], v1, s[20:23], s42 offen offset:3072
on3020:
    s_cmp_lt_u32 s13, 6
    s_cbranch_scc1 p3_go
    s_add_u32 s42, s80, 1478656
    buffer_load_dwordx4 a[144:147], v1, s[20:23], s42 offen offset:0
    buffer_load_dwordx4 a[148:151], v1, s[20:23], s42 offen offset:1024
    buffer_load_dwordx4 a[152:155], v1, s[20:23], s42 offen offset:2048
pad40:
    s_cbranch_execz pad72
    buffer_load_dwordx4 a[156:159], v1, s[20:23], s42 offen offset:3072
    s_add_u32 s42, s80, 1482752
    buffer_load_dwordx4 a[160:163], v1, s[20:23], s42 offen offset:0
    buffer_load_dwordx4 a[164:167], v1, s[20:23], s42 offen offset:1024
    buffer_load_dwordx4 a[168:171], v1, s[20:23], s42 offen offset:2048
    buffer_load_dwordx4 a[172:175], v1, s[20:23], s42 offen offset:3072
    s_add_u32 s42, s80, 1486848
    buffer_load_dwordx4 a[176:179], v1, s[20:23], s42 offen offset:0
    buffer_load_dwordx4 a[180:183], v1, s[20:23], s42 offen offset:1024
    buffer_load_dwordx4 a[184:187], v1, s[20:23], s42 offen offset:2048
    buffer_load_dwordx4 a[188:191], v1, s[20:23], s42 offen offset:3072
    s_add_u32 s42, s81, 1478656
    buffer_load_dwordx4 a[192:195], v1, s[20:23], s42 offen offset:0
    buffer_load_dwordx4 a[196:199], v1, s[20:23], s42 offen offset:1024
    buffer_load_dwordx4 a[200:203], v1, s[20:23], s42 offen offset:2048
    buffer_load_dwordx4 a[204:207], v1, s[20:23], s42 offen offset:3072
    s_add_u32 s42, s81, 1482752
    buffer_load_dwordx4 a[208:211], v1, s[20:23], s42 offen offset:0
    buffer_load_dwordx4 a[212:215], v1, s[20:23], s42 offen offset:1024
    buffer_load_dwordx4 a[216:219], v1, s[20:23], s42 offen offset:2048
    buffer_load_dwordx4 a[220:223], v1, s[20:23], s42 offen offset:3072
    s_add_u32 s42, s81, 1486848
    buffer_load_dwordx4 a[224:227], v1, s[20:23], s42 offen offset:0
    buffer_load_dwordx4 a[228:231], v1, s[20:23], s42 offen offset:1024
    buffer_load_dwordx4 a[232:235], v1, s[20:23], s42 offen offset:2048
    buffer_load_dwordx4 a[236:239], v1, s[20:23], s42 offen offset:3072
    s_branch p4_start
p3_go:
    s_cmp_lg_u32 s3, 3
    s_cbranch_scc1 kb_w3072_d
    s_mov_b32 s42, s45
    v_lshrrev_b32 v7, 3, v0
    v_lshlrev_b32 v7, 7, v7
    v_and_b32 v6, 7, v0
    v_lshl_add_u32 v7, v6, 2, v7
    s_mov_b32 s43, 0x40000
    s_mov_b32 exec_lo, 0xff
    s_mov_b32 exec_hi, 0x0
kb_w3072:
    buffer_load_dword v6, v5, s[20:23], s42 offen sc1
    s_sub_u32 s43, s43, 1
    s_cbranch_scc1 kb_w3072_x
    s_waitcnt vmcnt(0)
    v_cmp_ne_u32 vcc, 1, v6
    s_cbranch_vccnz kb_w3072
kb_w3072_x:
    s_mov_b64 exec, -1
kb_w3072_d:
    s_barrier
p3_re:
    s_min_u32 s43, s3, 2
    s_add_u32 s42, s14, s43
    s_lshl_b32 s42, s42, 10
    s_add_u32 s42, s42, 6217728
    v_lshlrev_b32 v6, 6, v3
    v_lshl_add_u32 v6, v2, 4, v6
    buffer_load_dwordx4 v[12:15], v6, s[20:23], s42 offen sc1
    s_add_u32 s32, s16, 5038080
    s_add_u32 s33, s16, 5050368
    s_add_u32 s34, s16, 5062656
    buffer_load_dwordx4 v[60:63], v1, s[20:23], s32 offen offset:0 sc1
    buffer_load_dwordx4 v[64:67], v1, s[20:23], s33 offen offset:0 sc1
    buffer_load_dwordx4 v[68:71], v1, s[20:23], s34 offen offset:0 sc1
    buffer_load_dwordx4 v[72:75], v1, s[20:23], s32 offen offset:1024 sc1
    buffer_load_dwordx4 v[76:79], v1, s[20:23], s33 offen offset:1024 sc1
    buffer_load_dwordx4 v[80:83], v1, s[20:23], s34 offen offset:1024 sc1
    buffer_load_dwordx4 v[84:87], v1, s[20:23], s32 offen offset:2048 sc1
    buffer_load_dwordx4 v[88:91], v1, s[20:23], s33 offen offset:2048 sc1
    buffer_load_dwordx4 v[92:95], v1, s[20:23], s34 offen offset:2048 sc1
    s_mul_i32 s42, s3, 9216
    v_add_u32 v6, s42, v1
    s_lshl_b32 s43, s43, 7
    s_add_u32 s43, s43, 73728
    v_lshl_add_u32 v7, v3, 3, s43
    s_waitcnt vmcnt(9)
pad41:
    s_cbranch_execz pad73
    v_max_u32 v8, v12, v14
    v_pk_add_f32 v[12:13], v[12:13], v[14:15]
    v_mov_b32 v14, v12
    s_nop 1
    v_permlane16_swap_b32 v12, v14
    s_nop 1
    v_add_f32 v12, v12, v14
    v_mov_b32 v14, v12
    s_nop 1
    v_permlane32_swap_b32 v12, v14
    s_nop 1
    v_add_f32 v12, v12, v14
    v_mov_b32 v14, v13
    s_nop 1
    v_permlane16_swap_b32 v13, v14
    s_nop 1
    v_add_f32 v13, v13, v14
    v_mov_b32 v14, v13
    s_nop 1
    v_permlane32_swap_b32 v13, v14
    s_nop 1
    v_add_f32 v13, v13, v14
    v_mul_f32 v12, 0x3b2aaaab, v12
    v_mul_f32 v13, 0x3b2aaaab, v13
    v_fma_f32 v13, -v12, v12, v13
    v_max_f32 v13, 0, v13
    v_add_f32 v13, 0x3727c5ac, v13
    v_rsq_f32 v13, v13
    s_nop 0
    ds_write_b64 v7, v[12:13]
    s_waitcnt vmcnt(8)
    ds_write_b128 v6, v[60:63] offset:0
    v_max_u32 v8, v8, v60
    s_waitcnt vmcnt(7)
    ds_write_b128 v6, v[64:67] offset:1024
    v_max_u32 v8, v8, v64
    s_waitcnt vmcnt(6)
    ds_write_b128 v6, v[68:71] offset:2048
    v_max_u32 v8, v8, v68
    s_waitcnt vmcnt(5)
    ds_write_b128 v6, v[72:75] offset:3072
    v_max_u32 v8, v8, v72
    s_waitcnt vmcnt(4)
    ds_write_b128 v6, v[76:79] offset:4096
    v_max_u32 v8, v8, v76
    s_waitcnt vmcnt(3)
    ds_write_b128 v6, v[80:83] offset:5120
    v_max_u32 v8, v8, v80
    s_waitcnt vmcnt(2)
    ds_write_b128 v6, v[84:87] offset:6144
    v_max_u32 v8, v8, v84
    s_waitcnt vmcnt(1)
    ds_write_b128 v6, v[88:91] offset:7168
    v_max_u32 v8, v8, v88
    s_waitcnt vmcnt(0)
    ds_write_b128 v6, v[92:95] offset:8192
    v_max_u32 v8, v8, v92
    s_waitcnt lgkmcnt(0)
    v_cmp_eq_u32 vcc, -1, v8
    s_cbranch_vccz p3_re_ok
    s_sub_u32 s40, s40, 1
    s_cbranch_scc0 p3_re
    s_mov_b32 s40, 0
p3_re_ok:
    s_barrier
    s_lshr_b32 s47, s12, 3
    s_lshl_b32 s47, s47, 2
    s_and_b32 s48, s13, 1
    s_lshl_b32 s48, s48, 1
    s_add_u32 s47, s47, s48
    s_lshr_b32 s48, s3, 1
    s_add_u32 s47, s47, s48
    s_mul_i32 s47, s47, 73728
    s_lshr_b32 s48, s13, 1
    s_mul_i32 s48, s48, 1179648
    s_add_u32 s47, s47, s48
    s_add_u32 s47, s47, 6316032
    s_and_b32 s48, s12, 7
    s_and_b32 s49, s3, 1
    s_cmp_ge_u32 s13, 4
    s_cbranch_scc1 p3_v
    s_mul_i32 s43, s3, 384
    s_add_u32 s43, s43, 74112
    v_lshlrev_b32 v7, 3, v3
    v_add_u32 v7, 73728, v7
    s_lshl_b32 s42, s65, 7
    s_add_u32 s42, s42, s43
pad42:
    s_cbranch_execz pad74
    v_lshl_add_u32 v6, v2, 5, s42
    ds_read_b128 v[100:103], v6
    ds_read_b128 v[104:107], v6 offset:16
    ds_read_b64 v[124:125], v7 offset:0
    s_lshl_b32 s42, s66, 7
    s_add_u32 s42, s42, s43
    v_lshl_add_u32 v6, v2, 5, s42
    ds_read_b128 v[108:111], v6
    ds_read_b128 v[112:115], v6 offset:16
    ds_read_b64 v[126:127], v7 offset:128
    s_lshl_b32 s42, s67, 7
    s_add_u32 s42, s42, s43
    v_lshl_add_u32 v6, v2, 5, s42
    ds_read_b128 v[116:119], v6
    ds_read_b128 v[120:123], v6 offset:16
    ds_read_b64 v[128:129], v7 offset:256
    ds_read_b128 v[60:63], v1 offset:0
    ds_read_b128 v[64:67], v1 offset:1024
    ds_read_b128 v[68:71], v1 offset:2048
    ds_read_b128 v[72:75], v1 offset:3072
    ds_read_b128 v[76:79], v1 offset:4096
    ds_read_b128 v[80:83], v1 offset:5120
    ds_read_b128 v[84:87], v1 offset:6144
    ds_read_b128 v[88:91], v1 offset:7168
    ds_read_b128 v[92:95], v1 offset:8192
    s_waitcnt lgkmcnt(6)
    v_mfma_f32_16x16x32_bf16 v[24:27], a[0:3], v[60:63], 0
    v_mfma_f32_16x16x32_bf16 v[28:31], a[48:51], v[60:63], 0
    v_mfma_f32_16x16x32_bf16 v[32:35], a[96:99], v[60:63], 0
    s_add_u32 s42, s80, 1478656
    buffer_load_dwordx4 a[144:147], v1, s[20:23], s42 offen
    v_mfma_f32_16x16x32_bf16 v[36:39], a[0:3], v[64:67], 0
    v_mfma_f32_16x16x32_bf16 v[40:43], a[48:51], v[64:67], 0
    v_mfma_f32_16x16x32_bf16 v[44:47], a[96:99], v[64:67], 0
    s_add_u32 s42, s81, 1478656
    buffer_load_dwordx4 a[192:195], v1, s[20:23], s42 offen
    v_mfma_f32_16x16x32_bf16 v[48:51], a[0:3], v[68:71], 0
    v_mfma_f32_16x16x32_bf16 v[52:55], a[48:51], v[68:71], 0
    v_mfma_f32_16x16x32_bf16 v[56:59], a[96:99], v[68:71], 0
    ds_read_b128 v[60:63], v1 offset:9216
    ds_read_b128 v[64:67], v1 offset:10240
    ds_read_b128 v[68:71], v1 offset:11264
    s_waitcnt lgkmcnt(6)
    v_mfma_f32_16x16x32_bf16 v[24:27], a[4:7], v[72:75], v[24:27]
    v_mfma_f32_16x16x32_bf16 v[28:31], a[52:55], v[72:75], v[28:31]
    v_mfma_f32_16x16x32_bf16 v[32:35], a[100:103], v[72:75], v[32:35]
    s_add_u32 s42, s80, 1479680
    buffer_load_dwordx4 a[148:151], v1, s[20:23], s42 offen
    v_mfma_f32_16x16x32_bf16 v[36:39], a[4:7], v[76:79], v[36:39]
    v_mfma_f32_16x16x32_bf16 v[40:43], a[52:55], v[76:79], v[40:43]
    v_mfma_f32_16x16x32_bf16 v[44:47], a[100:103], v[76:79], v[44:47]
    s_add_u32 s42, s81, 1479680
    buffer_load_dwordx4 a[196:199], v1, s[20:23], s42 offen
    v_mfma_f32_16x16x32_bf16 v[48:51], a[4:7], v[80:83], v[48:51]
    v_mfma_f32_16x16x32_bf16 v[52:55], a[52:55], v[80:83], v[52:55]
    v_mfma_f32_16x16x32_bf16 v[56:59], a[100:103], v[80:83], v[56:59]
    ds_read_b128 v[72:75], v1 offset:12288
    ds_read_b128 v[76:79], v1 offset:13312
    ds_read_b128 v[80:83], v1 offset:14336
    s_waitcnt lgkmcnt(6)
    v_mfma_f32_16x16x32_bf16 v[24:27], a[8:11], v[84:87], v[24:27]
    v_mfma_f32_16x16x32_bf16 v[28:31], a[56:59], v[84:87], v[28:31]
    v_mfma_f32_16x16x32_bf16 v[32:35], a[104:107], v[84:87], v[32:35]
    s_add_u32 s42, s80, 1480704
    buffer_load_dwordx4 a[152:155], v1, s[20:23], s42 offen
pad43:
    s_cbranch_execz pad75
    v_mfma_f32_16x16x32_bf16 v[36:39], a[8:11], v[88:91], v[36:39]
    v_mfma_f32_16x16x32_bf16 v[40:43], a[56:59], v[88:91], v[40:43]
    v_mfma_f32_16x16x32_bf16 v[44:47], a[104:107], v[88:91], v[44:47]
    s_add_u32 s42, s81, 1480704
    buffer_load_dwordx4 a[200:203], v1, s[20:23], s42 offen
    v_mfma_f32_16x16x32_bf16 v[48:51], a[8:11], v[92:95], v[48:51]
    v_mfma_f32_16x16x32_bf16 v[52:55], a[56:59], v[92:95], v[52:55]
    v_mfma_f32_16x16x32_bf16 v[56:59], a[104:107], v[92:95], v[56:59]
    ds_read_b128 v[84:87], v1 offset:15360
    ds_read_b128 v[88:91], v1 offset:16384
    ds_read_b128 v[92:95], v1 offset:17408
    s_waitcnt lgkmcnt(6)
    v_mfma_f32_16x16x32_bf16 v[24:27], a[12:15], v[60:63], v[24:27]
    v_mfma_f32_16x16x32_bf16 v[28:31], a[60:63], v[60:63], v[28:31]
    v_mfma_f32_16x16x32_bf16 v[32:35], a[108:111], v[60:63], v[32:35]
    s_add_u32 s42, s80, 1481728
    buffer_load_dwordx4 a[156:159], v1, s[20:23], s42 offen
    v_mfma_f32_16x16x32_bf16 v[36:39], a[12:15], v[64:67], v[36:39]
    v_mfma_f32_16x16x32_bf16 v[40:43], a[60:63], v[64:67], v[40:43]
    v_mfma_f32_16x16x32_bf16 v[44:47], a[108:111], v[64:67], v[44:47]
    s_add_u32 s42, s81, 1481728
    buffer_load_dwordx4 a[204:207], v1, s[20:23], s42 offen
    v_mfma_f32_16x16x32_bf16 v[48:51], a[12:15], v[68:71], v[48:51]
    v_mfma_f32_16x16x32_bf16 v[52:55], a[60:63], v[68:71], v[52:55]
    v_mfma_f32_16x16x32_bf16 v[56:59], a[108:111], v[68:71], v[56:59]
    ds_read_b128 v[60:63], v1 offset:18432
    ds_read_b128 v[64:67], v1 offset:19456
    ds_read_b128 v[68:71], v1 offset:20480
    s_waitcnt lgkmcnt(6)
    v_mfma_f32_16x16x32_bf16 v[24:27], a[16:19], v[72:75], v[24:27]
    v_mfma_f32_16x16x32_bf16 v[28:31], a[64:67], v[72:75], v[28:31]
    v_mfma_f32_16x16x32_bf16 v[32:35], a[112:115], v[72:75], v[32:35]
    s_add_u32 s42, s80, 1482752
    buffer_load_dwordx4 a[160:163], v1, s[20:23], s42 offen
    v_mfma_f32_16x16x32_bf16 v[36:39], a[16:19], v[76:79], v[36:39]
    v_mfma_f32_16x16x32_bf16 v[40:43], a[64:67], v[76:79], v[40:43]
    v_mfma_f32_16x16x32_bf16 v[44:47], a[112:115], v[76:79], v[44:47]
    s_add_u32 s42, s81, 1482752
    buffer_load_dwordx4 a[208:211], v1, s[20:23], s42 offen
    v_mfma_f32_16x16x32_bf16 v[48:51], a[16:19], v[80:83], v[48:51]
    v_mfma_f32_16x16x32_bf16 v[52:55], a[64:67], v[80:83], v[52:55]
    v_mfma_f32_16x16x32_bf16 v[56:59], a[112:115], v[80:83], v[56:59]
    ds_read_b128 v[72:75], v1 offset:21504
    ds_read_b128 v[76:79], v1 offset:22528
    ds_read_b128 v[80:83], v1 offset:23552
    s_waitcnt lgkmcnt(6)
    v_mfma_f32_16x16x32_bf16 v[24:27], a[20:23], v[84:87], v[24:27]
    v_mfma_f32_16x16x32_bf16 v[28:31], a[68:71], v[84:87], v[28:31]
    v_mfma_f32_16x16x32_bf16 v[32:35], a[116:119], v[84:87], v[32:35]
    s_add_u32 s42, s80, 1483776
    buffer_load_dwordx4 a[164:167], v1, s[20:23], s42 offen
    v_mfma_f32_16x16x32_bf16 v[36:39], a[20:23], v[88:91], v[36:39]
    v_mfma_f32_16x16x32_bf16 v[40:43], a[68:71], v[88:91], v[40:43]
    v_mfma_f32_16x16x32_bf16 v[44:47], a[116:119], v[88:91], v[44:47]
    s_add_u32 s42, s81, 1483776
    buffer_load_dwordx4 a[212:215], v1, s[20:23], s42 offen
    v_mfma_f32_16x16x32_bf16 v[48:51], a[20:23], v[92:95], v[48:51]
    v_mfma_f32_16x16x32_bf16 v[52:55], a[68:71], v[92:95], v[52:55]
    v_mfma_f32_16x16x32_bf16 v[56:59], a[116:119], v[92:95], v[56:59]
    ds_read_b128 v[84:87], v1 offset:24576
    ds_read_b128 v[88:91], v1 offset:25600
    ds_read_b128 v[92:95], v1 offset:26624
    s_waitcnt lgkmcnt(6)
    v_mfma_f32_16x16x32_bf16 v[24:27], a[24:27], v[60:63], v[24:27]
    v_mfma_f32_16x16x32_bf16 v[28:31], a[72:75], v[60:63], v[28:31]
    v_mfma_f32_16x16x32_bf16 v[32:35], a[120:123], v[60:63], v[32:35]
pad44:
    s_cbranch_execz pad76
    s_add_u32 s42, s80, 1484800
    buffer_load_dwordx4 a[168:171], v1, s[20:23], s42 offen
    v_mfma_f32_16x16x32_bf16 v[36:39], a[24:27], v[64:67], v[36:39]
    v_mfma_f32_16x16x32_bf16 v[40:43], a[72:75], v[64:67], v[40:43]
    v_mfma_f32_16x16x32_bf16 v[44:47], a[120:123], v[64:67], v[44:47]
    s_add_u32 s42, s81, 1484800
    buffer_load_dwordx4 a[216:219], v1, s[20:23], s42 offen
    v_mfma_f32_16x16x32_bf16 v[48:51], a[24:27], v[68:71], v[48:51]
    v_mfma_f32_16x16x32_bf16 v[52:55], a[72:75], v[68:71], v[52:55]
    v_mfma_f32_16x16x32_bf16 v[56:59], a[120:123], v[68:71], v[56:59]
    ds_read_b128 v[60:63], v1 offset:27648
    ds_read_b128 v[64:67], v1 offset:28672
    ds_read_b128 v[68:71], v1 offset:29696
    s_waitcnt lgkmcnt(6)
    v_mfma_f32_16x16x32_bf16 v[24:27], a[28:31], v[72:75], v[24:27]
    v_mfma_f32_16x16x32_bf16 v[28:31], a[76:79], v[72:75], v[28:31]
    v_mfma_f32_16x16x32_bf16 v[32:35], a[124:127], v[72:75], v[32:35]
    s_add_u32 s42, s80, 1485824
    buffer_load_dwordx4 a[172:175], v1, s[20:23], s42 offen
    v_mfma_f32_16x16x32_bf16 v[36:39], a[28:31], v[76:79], v[36:39]
    v_mfma_f32_16x16x32_bf16 v[40:43], a[76:79], v[76:79], v[40:43]
    v_mfma_f32_16x16x32_bf16 v[44:47], a[124:127], v[76:79], v[44:47]
    s_add_u32 s42, s81, 1485824
    buffer_load_dwordx4 a[220:223], v1, s[20:23], s42 offen
    v_mfma_f32_16x16x32_bf16 v[48:51], a[28:31], v[80:83], v[48:51]
    v_mfma_f32_16x16x32_bf16 v[52:55], a[76:79], v[80:83], v[52:55]
    v_mfma_f32_16x16x32_bf16 v[56:59], a[124:127], v[80:83], v[56:59]
    ds_read_b128 v[72:75], v1 offset:30720
    ds_read_b128 v[76:79], v1 offset:31744
    ds_read_b128 v[80:83], v1 offset:32768
    s_waitcnt lgkmcnt(6)
    v_mfma_f32_16x16x32_bf16 v[24:27], a[32:35], v[84:87], v[24:27]
    v_mfma_f32_16x16x32_bf16 v[28:31], a[80:83], v[84:87], v[28:31]
    v_mfma_f32_16x16x32_bf16 v[32:35], a[128:131], v[84:87], v[32:35]
    s_add_u32 s42, s80, 1486848
    buffer_load_dwordx4 a[176:179], v1, s[20:23], s42 offen
    v_mfma_f32_16x16x32_bf16 v[36:39], a[32:35], v[88:91], v[36:39]
    v_mfma_f32_16x16x32_bf16 v[40:43], a[80:83], v[88:91], v[40:43]
    v_mfma_f32_16x16x32_bf16 v[44:47], a[128:131], v[88:91], v[44:47]
    s_add_u32 s42, s81, 1486848
    buffer_load_dwordx4 a[224:227], v1, s[20:23], s42 offen
    v_mfma_f32_16x16x32_bf16 v[48:51], a[32:35], v[92:95], v[48:51]
    v_mfma_f32_16x16x32_bf16 v[52:55], a[80:83], v[92:95], v[52:55]
    v_mfma_f32_16x16x32_bf16 v[56:59], a[128:131], v[92:95], v[56:59]
    ds_read_b128 v[84:87], v1 offset:33792
    ds_read_b128 v[88:91], v1 offset:34816
    ds_read_b128 v[92:95], v1 offset:35840
    s_waitcnt lgkmcnt(6)
    v_mfma_f32_16x16x32_bf16 v[24:27], a[36:39], v[60:63], v[24:27]
    v_mfma_f32_16x16x32_bf16 v[28:31], a[84:87], v[60:63], v[28:31]
    v_mfma_f32_16x16x32_bf16 v[32:35], a[132:135], v[60:63], v[32:35]
    s_add_u32 s42, s80, 1487872
    buffer_load_dwordx4 a[180:183], v1, s[20:23], s42 offen
    v_mfma_f32_16x16x32_bf16 v[36:39], a[36:39], v[64:67], v[36:39]
    v_mfma_f32_16x16x32_bf16 v[40:43], a[84:87], v[64:67], v[40:43]
    v_mfma_f32_16x16x32_bf16 v[44:47], a[132:135], v[64:67], v[44:47]
    s_add_u32 s42, s81, 1487872
    buffer_load_dwordx4 a[228:231], v1, s[20:23], s42 offen
    v_mfma_f32_16x16x32_bf16 v[48:51], a[36:39], v[68:71], v[48:51]
    v_mfma_f32_16x16x32_bf16 v[52:55], a[84:87], v[68:71], v[52:55]
    v_mfma_f32_16x16x32_bf16 v[56:59], a[132:135], v[68:71], v[56:59]
    s_waitcnt lgkmcnt(3)
    v_mfma_f32_16x16x32_bf16 v[24:27], a[40:43], v[72:75], v[24:27]
    v_mfma_f32_16x16x32_bf16 v[28:31], a[88:91], v[72:75], v[28:31]
    v_mfma_f32_16x16x32_bf16 v[32:35], a[136:139], v[72:75], v[32:35]
    s_add_u32 s42, s80, 1488896
pad45:
    s_cbranch_execz wretB
    buffer_load_dwordx4 a[184:187], v1, s[20:23], s42 offen
    v_mfma_f32_16x16x32_bf16 v[36:39], a[40:43], v[76:79], v[36:39]
    v_mfma_f32_16x16x32_bf16 v[40:43], a[88:91], v[76:79], v[40:43]
    v_mfma_f32_16x16x32_bf16 v[44:47], a[136:139], v[76:79], v[44:47]
    s_add_u32 s42, s81, 1488896
    buffer_load_dwordx4 a[232:235], v1, s[20:23], s42 offen
    v_mfma_f32_16x16x32_bf16 v[48:51], a[40:43], v[80:83], v[48:51]
    v_mfma_f32_16x16x32_bf16 v[52:55], a[88:91], v[80:83], v[52:55]
    v_mfma_f32_16x16x32_bf16 v[56:59], a[136:139], v[80:83], v[56:59]
    s_waitcnt lgkmcnt(0)
    v_mfma_f32_16x16x32_bf16 v[24:27], a[44:47], v[84:87], v[24:27]
    v_mfma_f32_16x16x32_bf16 v[28:31], a[92:95], v[84:87], v[28:31]
    v_mfma_f32_16x16x32_bf16 v[32:35], a[140:143], v[84:87], v[32:35]
    s_add_u32 s42, s80, 1489920
    buffer_load_dwordx4 a[188:191], v1, s[20:23], s42 offen
    v_mfma_f32_16x16x32_bf16 v[36:39], a[44:47], v[88:91], v[36:39]
    v_mfma_f32_16x16x32_bf16 v[40:43], a[92:95], v[88:91], v[40:43]
    v_mfma_f32_16x16x32_bf16 v[44:47], a[140:143], v[88:91], v[44:47]
    s_add_u32 s42, s81, 1489920
    buffer_load_dwordx4 a[236:239], v1, s[20:23], s42 offen
    v_mfma_f32_16x16x32_bf16 v[48:51], a[44:47], v[92:95], v[48:51]
    v_mfma_f32_16x16x32_bf16 v[52:55], a[92:95], v[92:95], v[52:55]
    v_mfma_f32_16x16x32_bf16 v[56:59], a[140:143], v[92:95], v[56:59]
    s_mul_i32 s48, s48, 9216
    s_add_u32 s47, s47, s48
    s_add_u32 s50, s47, s70
    s_add_u32 s51, s47, s71
    s_add_u32 s52, s51, 6144
    v_and_b32 v6, 1, v2
    v_mul_u32_u24 v6, 3072, v6
    v_add_u32 v6, v6, v23
    v_fma_f32 v24, -v100, v124, v24
    v_mul_f32 v24, v24, v125
    v_fma_f32 v25, -v102, v124, v25
    v_mul_f32 v25, v25, v125
    v_fma_f32 v26, -v104, v124, v26
    v_mul_f32 v26, v26, v125
    v_fma_f32 v27, -v106, v124, v27
    v_mul_f32 v27, v27, v125
    v_fma_f32 v28, -v108, v124, v28
    v_mul_f32 v28, v28, v125
    v_fma_f32 v29, -v110, v124, v29
    v_mul_f32 v29, v29, v125
    v_fma_f32 v30, -v112, v124, v30
    v_mul_f32 v30, v30, v125
    v_fma_f32 v31, -v114, v124, v31
    v_mul_f32 v31, v31, v125
    v_fma_f32 v32, -v116, v124, v32
    v_mul_f32 v32, v32, v125
    v_fma_f32 v33, -v118, v124, v33
    v_mul_f32 v33, v33, v125
    v_fma_f32 v34, -v120, v124, v34
    v_mul_f32 v34, v34, v125
    v_fma_f32 v35, -v122, v124, v35
    v_mul_f32 v35, v35, v125
    v_cvt_pk_bf16_f32 v60, v24, v25
    v_cvt_pk_bf16_f32 v61, v26, v27
    v_cvt_pk_bf16_f32 v62, v28, v29
    v_cvt_pk_bf16_f32 v63, v30, v31
    buffer_store_dwordx4 v[60:63], v1, s[20:23], s50 offen sc1
    s_add_u32 s50, s50, 3072
    v_cvt_pk_bf16_f32 v72, v32, v33
    v_cvt_pk_bf16_f32 v73, v34, v35
    v_fma_f32 v36, -v100, v126, v36
    v_mul_f32 v36, v36, v127
    v_fma_f32 v37, -v102, v126, v37
    v_mul_f32 v37, v37, v127
    v_fma_f32 v38, -v104, v126, v38
    v_mul_f32 v38, v38, v127
    v_fma_f32 v39, -v106, v126, v39
    v_mul_f32 v39, v39, v127
    v_fma_f32 v40, -v108, v126, v40
    v_mul_f32 v40, v40, v127
    v_fma_f32 v41, -v110, v126, v41
pad46:
    s_cbranch_execz wretB
    v_mul_f32 v41, v41, v127
    v_fma_f32 v42, -v112, v126, v42
    v_mul_f32 v42, v42, v127
    v_fma_f32 v43, -v114, v126, v43
    v_mul_f32 v43, v43, v127
    v_fma_f32 v44, -v116, v126, v44
    v_mul_f32 v44, v44, v127
    v_fma_f32 v45, -v118, v126, v45
    v_mul_f32 v45, v45, v127
    v_fma_f32 v46, -v120, v126, v46
    v_mul_f32 v46, v46, v127
    v_fma_f32 v47, -v122, v126, v47
    v_mul_f32 v47, v47, v127
    v_cvt_pk_bf16_f32 v64, v36, v37
    v_cvt_pk_bf16_f32 v65, v38, v39
    v_cvt_pk_bf16_f32 v66, v40, v41
    v_cvt_pk_bf16_f32 v67, v42, v43
    buffer_store_dwordx4 v[64:67], v1, s[20:23], s50 offen sc1
    s_add_u32 s50, s50, 3072
    v_cvt_pk_bf16_f32 v74, v44, v45
    v_cvt_pk_bf16_f32 v75, v46, v47
    s_nop 1
    v_permlane16_swap_b32 v72, v74
    v_permlane16_swap_b32 v73, v75
    buffer_store_dwordx4 v[72:75], v6, s[20:23], s51 offen sc1
    v_fma_f32 v48, -v100, v128, v48
    v_mul_f32 v48, v48, v129
    v_fma_f32 v49, -v102, v128, v49
    v_mul_f32 v49, v49, v129
    v_fma_f32 v50, -v104, v128, v50
    v_mul_f32 v50, v50, v129
    v_fma_f32 v51, -v106, v128, v51
    v_mul_f32 v51, v51, v129
    v_fma_f32 v52, -v108, v128, v52
    v_mul_f32 v52, v52, v129
    v_fma_f32 v53, -v110, v128, v53
    v_mul_f32 v53, v53, v129
    v_fma_f32 v54, -v112, v128, v54
    v_mul_f32 v54, v54, v129
    v_fma_f32 v55, -v114, v128, v55
    v_mul_f32 v55, v55, v129
    v_fma_f32 v56, -v116, v128, v56
    v_mul_f32 v56, v56, v129
    v_fma_f32 v57, -v118, v128, v57
    v_mul_f32 v57, v57, v129
    v_fma_f32 v58, -v120, v128, v58
    v_mul_f32 v58, v58, v129
    v_fma_f32 v59, -v122, v128, v59
    v_mul_f32 v59, v59, v129
    v_cvt_pk_bf16_f32 v68, v48, v49
    v_cvt_pk_bf16_f32 v69, v50, v51
    v_cvt_pk_bf16_f32 v70, v52, v53
    v_cvt_pk_bf16_f32 v71, v54, v55
    buffer_store_dwordx4 v[68:71], v1, s[20:23], s50 offen sc1
    v_cvt_pk_bf16_f32 v76, v56, v57
    v_cvt_pk_bf16_f32 v77, v58, v59
    v_mov_b32 v78, v76
    v_mov_b32 v79, v77
    s_nop 1
    v_permlane16_swap_b32 v76, v78
    v_permlane16_swap_b32 v77, v79
    s_mov_b64 exec, s[72:73]
    buffer_store_dwordx4 v[76:79], v23, s[20:23], s52 offen sc1
    s_mov_b64 exec, -1
    s_branch p3_done
p3_v:
    s_and_b32 s42, s12, 1
    s_mov_b32 s83, s42
    s_add_u32 s84, s42, 1
    s_cmp_eq_u32 s42, 1
    s_cselect_b32 s85, 0, 2
    s_mul_i32 s43, s3, 384
    s_add_u32 s43, s43, 74112
    s_lshl_b32 s42, s83, 10
    v_add_u32 v13, s42, v1
    s_lshl_b32 s42, s83, 7
    s_add_u32 s42, s42, 73728
pad47:
    s_cbranch_execz wretB
    v_lshl_add_u32 v6, v2, 5, s42
    s_lshl_b32 s42, s65, 7
    s_add_u32 s42, s42, s43
    v_lshl_add_u32 v7, v3, 3, s42
    ds_read_b128 v[100:103], v6
    ds_read_b128 v[104:107], v6 offset:16
    ds_read_b64 v[124:125], v7
    s_lshl_b32 s42, s84, 10
    v_add_u32 v14, s42, v1
    s_lshl_b32 s42, s84, 7
    s_add_u32 s42, s42, 73728
    v_lshl_add_u32 v6, v2, 5, s42
    s_lshl_b32 s42, s66, 7
    s_add_u32 s42, s42, s43
    v_lshl_add_u32 v7, v3, 3, s42
    ds_read_b128 v[108:111], v6
    ds_read_b128 v[112:115], v6 offset:16
    ds_read_b64 v[126:127], v7
    s_lshl_b32 s42, s85, 10
    v_add_u32 v15, s42, v1
    s_lshl_b32 s42, s85, 7
    s_add_u32 s42, s42, 73728
    v_lshl_add_u32 v6, v2, 5, s42
    s_lshl_b32 s42, s67, 7
    s_add_u32 s42, s42, s43
    v_lshl_add_u32 v7, v3, 3, s42
    ds_read_b128 v[116:119], v6
    ds_read_b128 v[120:123], v6 offset:16
    ds_read_b64 v[128:129], v7
    ds_read_b128 v[60:63], v13 offset:0
    ds_read_b128 v[64:67], v14 offset:0
    ds_read_b128 v[68:71], v15 offset:0
    ds_read_b128 v[72:75], v13 offset:3072
    ds_read_b128 v[76:79], v14 offset:3072
    ds_read_b128 v[80:83], v15 offset:3072
    ds_read_b128 v[84:87], v13 offset:6144
    ds_read_b128 v[88:91], v14 offset:6144
    ds_read_b128 v[92:95], v15 offset:6144
    s_waitcnt lgkmcnt(6)
    v_mfma_f32_16x16x32_bf16 v[24:27], v[60:63], a[0:3], 0
    v_mfma_f32_16x16x32_bf16 v[28:31], v[60:63], a[48:51], 0
    v_mfma_f32_16x16x32_bf16 v[32:35], v[60:63], a[96:99], 0
    s_add_u32 s42, s80, 1478656
    buffer_load_dwordx4 a[144:147], v1, s[20:23], s42 offen
    v_mfma_f32_16x16x32_bf16 v[36:39], v[64:67], a[0:3], 0
    v_mfma_f32_16x16x32_bf16 v[40:43], v[64:67], a[48:51], 0
    v_mfma_f32_16x16x32_bf16 v[44:47], v[64:67], a[96:99], 0
    s_add_u32 s42, s81, 1478656
    buffer_load_dwordx4 a[192:195], v1, s[20:23], s42 offen
    v_mfma_f32_16x16x32_bf16 v[48:51], v[68:71], a[0:3], 0
    v_mfma_f32_16x16x32_bf16 v[52:55], v[68:71], a[48:51], 0
    v_mfma_f32_16x16x32_bf16 v[56:59], v[68:71], a[96:99], 0
    ds_read_b128 v[60:63], v13 offset:9216
    ds_read_b128 v[64:67], v14 offset:9216
    ds_read_b128 v[68:71], v15 offset:9216
    s_waitcnt lgkmcnt(6)
    v_mfma_f32_16x16x32_bf16 v[24:27], v[72:75], a[4:7], v[24:27]
    v_mfma_f32_16x16x32_bf16 v[28:31], v[72:75], a[52:55], v[28:31]
    v_mfma_f32_16x16x32_bf16 v[32:35], v[72:75], a[100:103], v[32:35]
    s_add_u32 s42, s80, 1479680
    buffer_load_dwordx4 a[148:151], v1, s[20:23], s42 offen
    v_mfma_f32_16x16x32_bf16 v[36:39], v[76:79], a[4:7], v[36:39]
    v_mfma_f32_16x16x32_bf16 v[40:43], v[76:79], a[52:55], v[40:43]
    v_mfma_f32_16x16x32_bf16 v[44:47], v[76:79], a[100:103], v[44:47]
    s_add_u32 s42, s81, 1479680
    buffer_load_dwordx4 a[196:199], v1, s[20:23], s42 offen
pad48:
    s_cbranch_execz wretB
    v_mfma_f32_16x16x32_bf16 v[48:51], v[80:83], a[4:7], v[48:51]
    v_mfma_f32_16x16x32_bf16 v[52:55], v[80:83], a[52:55], v[52:55]
    v_mfma_f32_16x16x32_bf16 v[56:59], v[80:83], a[100:103], v[56:59]
    ds_read_b128 v[72:75], v13 offset:12288
    ds_read_b128 v[76:79], v14 offset:12288
    ds_read_b128 v[80:83], v15 offset:12288
    s_waitcnt lgkmcnt(6)
    v_mfma_f32_16x16x32_bf16 v[24:27], v[84:87], a[8:11], v[24:27]
    v_mfma_f32_16x16x32_bf16 v[28:31], v[84:87], a[56:59], v[28:31]
    v_mfma_f32_16x16x32_bf16 v[32:35], v[84:87], a[104:107], v[32:35]
    s_add_u32 s42, s80, 1480704
    buffer_load_dwordx4 a[152:155], v1, s[20:23], s42 offen
    v_mfma_f32_16x16x32_bf16 v[36:39], v[88:91], a[8:11], v[36:39]
    v_mfma_f32_16x16x32_bf16 v[40:43], v[88:91], a[56:59], v[40:43]
    v_mfma_f32_16x16x32_bf16 v[44:47], v[88:91], a[104:107], v[44:47]
    s_add_u32 s42, s81, 1480704
    buffer_load_dwordx4 a[200:203], v1, s[20:23], s42 offen
    v_mfma_f32_16x16x32_bf16 v[48:51], v[92:95], a[8:11], v[48:51]
    v_mfma_f32_16x16x32_bf16 v[52:55], v[92:95], a[56:59], v[52:55]
    v_mfma_f32_16x16x32_bf16 v[56:59], v[92:95], a[104:107], v[56:59]
    ds_read_b128 v[84:87], v13 offset:15360
    ds_read_b128 v[88:91], v14 offset:15360
    ds_read_b128 v[92:95], v15 offset:15360
    s_waitcnt lgkmcnt(6)
    v_mfma_f32_16x16x32_bf16 v[24:27], v[60:63], a[12:15], v[24:27]
    v_mfma_f32_16x16x32_bf16 v[28:31], v[60:63], a[60:63], v[28:31]
    v_mfma_f32_16x16x32_bf16 v[32:35], v[60:63], a[108:111], v[32:35]
    s_add_u32 s42, s80, 1481728
    buffer_load_dwordx4 a[156:159], v1, s[20:23], s42 offen
    v_mfma_f32_16x16x32_bf16 v[36:39], v[64:67], a[12:15], v[36:39]
    v_mfma_f32_16x16x32_bf16 v[40:43], v[64:67], a[60:63], v[40:43]
    v_mfma_f32_16x16x32_bf16 v[44:47], v[64:67], a[108:111], v[44:47]
    s_add_u32 s42, s81, 1481728
    buffer_load_dwordx4 a[204:207], v1, s[20:23], s42 offen
    v_mfma_f32_16x16x32_bf16 v[48:51], v[68:71], a[12:15], v[48:51]
    v_mfma_f32_16x16x32_bf16 v[52:55], v[68:71], a[60:63], v[52:55]
    v_mfma_f32_16x16x32_bf16 v[56:59], v[68:71], a[108:111], v[56:59]
    ds_read_b128 v[60:63], v13 offset:18432
    ds_read_b128 v[64:67], v14 offset:18432
    ds_read_b128 v[68:71], v15 offset:18432
    s_waitcnt lgkmcnt(6)
    v_mfma_f32_16x16x32_bf16 v[24:27], v[72:75], a[16:19], v[24:27]
    v_mfma_f32_16x16x32_bf16 v[28:31], v[72:75], a[64:67], v[28:31]
    v_mfma_f32_16x16x32_bf16 v[32:35], v[72:75], a[112:115], v[32:35]
    s_add_u32 s42, s80, 1482752
    buffer_load_dwordx4 a[160:163], v1, s[20:23], s42 offen
    v_mfma_f32_16x16x32_bf16 v[36:39], v[76:79], a[16:19], v[36:39]
    v_mfma_f32_16x16x32_bf16 v[40:43], v[76:79], a[64:67], v[40:43]
    v_mfma_f32_16x16x32_bf16 v[44:47], v[76:79], a[112:115], v[44:47]
    s_add_u32 s42, s81, 1482752
    buffer_load_dwordx4 a[208:211], v1, s[20:23], s42 offen
    v_mfma_f32_16x16x32_bf16 v[48:51], v[80:83], a[16:19], v[48:51]
    v_mfma_f32_16x16x32_bf16 v[52:55], v[80:83], a[64:67], v[52:55]
    v_mfma_f32_16x16x32_bf16 v[56:59], v[80:83], a[112:115], v[56:59]
    ds_read_b128 v[72:75], v13 offset:21504
    ds_read_b128 v[76:79], v14 offset:21504
    ds_read_b128 v[80:83], v15 offset:21504
    s_waitcnt lgkmcnt(6)
    v_mfma_f32_16x16x32_bf16 v[24:27], v[84:87], a[20:23], v[24:27]
    v_mfma_f32_16x16x32_bf16 v[28:31], v[84:87], a[68:71], v[28:31]
    v_mfma_f32_16x16x32_bf16 v[32:35], v[84:87], a[116:119], v[32:35]
    s_add_u32 s42, s80, 1483776
    buffer_load_dwordx4 a[164:167], v1, s[20:23], s42 offen
    v_mfma_f32_16x16x32_bf16 v[36:39], v[88:91], a[20:23], v[36:39]
    v_mfma_f32_16x16x32_bf16 v[40:43], v[88:91], a[68:71], v[40:43]
    v_mfma_f32_16x16x32_bf16 v[44:47], v[88:91], a[116:119], v[44:47]
pad49:
    s_cbranch_execz wretB
    s_add_u32 s42, s81, 1483776
    buffer_load_dwordx4 a[212:215], v1, s[20:23], s42 offen
    v_mfma_f32_16x16x32_bf16 v[48:51], v[92:95], a[20:23], v[48:51]
    v_mfma_f32_16x16x32_bf16 v[52:55], v[92:95], a[68:71], v[52:55]
    v_mfma_f32_16x16x32_bf16 v[56:59], v[92:95], a[116:119], v[56:59]
    ds_read_b128 v[84:87], v13 offset:24576
    ds_read_b128 v[88:91], v14 offset:24576
    ds_read_b128 v[92:95], v15 offset:24576
    s_waitcnt lgkmcnt(6)
    v_mfma_f32_16x16x32_bf16 v[24:27], v[60:63], a[24:27], v[24:27]
    v_mfma_f32_16x16x32_bf16 v[28:31], v[60:63], a[72:75], v[28:31]
    v_mfma_f32_16x16x32_bf16 v[32:35], v[60:63], a[120:123], v[32:35]
    s_add_u32 s42, s80, 1484800
    buffer_load_dwordx4 a[168:171], v1, s[20:23], s42 offen
    v_mfma_f32_16x16x32_bf16 v[36:39], v[64:67], a[24:27], v[36:39]
    v_mfma_f32_16x16x32_bf16 v[40:43], v[64:67], a[72:75], v[40:43]
    v_mfma_f32_16x16x32_bf16 v[44:47], v[64:67], a[120:123], v[44:47]
    s_add_u32 s42, s81, 1484800
    buffer_load_dwordx4 a[216:219], v1, s[20:23], s42 offen
    v_mfma_f32_16x16x32_bf16 v[48:51], v[68:71], a[24:27], v[48:51]
    v_mfma_f32_16x16x32_bf16 v[52:55], v[68:71], a[72:75], v[52:55]
    v_mfma_f32_16x16x32_bf16 v[56:59], v[68:71], a[120:123], v[56:59]
    ds_read_b128 v[60:63], v13 offset:27648
    ds_read_b128 v[64:67], v14 offset:27648
    ds_read_b128 v[68:71], v15 offset:27648
    s_waitcnt lgkmcnt(6)
    v_mfma_f32_16x16x32_bf16 v[24:27], v[72:75], a[28:31], v[24:27]
    v_mfma_f32_16x16x32_bf16 v[28:31], v[72:75], a[76:79], v[28:31]
    v_mfma_f32_16x16x32_bf16 v[32:35], v[72:75], a[124:127], v[32:35]
    s_add_u32 s42, s80, 1485824
    buffer_load_dwordx4 a[172:175], v1, s[20:23], s42 offen
    v_mfma_f32_16x16x32_bf16 v[36:39], v[76:79], a[28:31], v[36:39]
    v_mfma_f32_16x16x32_bf16 v[40:43], v[76:79], a[76:79], v[40:43]
    v_mfma_f32_16x16x32_bf16 v[44:47], v[76:79], a[124:127], v[44:47]
    s_add_u32 s42, s81, 1485824
    buffer_load_dwordx4 a[220:223], v1, s[20:23], s42 offen
    v_mfma_f32_16x16x32_bf16 v[48:51], v[80:83], a[28:31], v[48:51]
    v_mfma_f32_16x16x32_bf16 v[52:55], v[80:83], a[76:79], v[52:55]
    v_mfma_f32_16x16x32_bf16 v[56:59], v[80:83], a[124:127], v[56:59]
    ds_read_b128 v[72:75], v13 offset:30720
    ds_read_b128 v[76:79], v14 offset:30720
    ds_read_b128 v[80:83], v15 offset:30720
    s_waitcnt lgkmcnt(6)
    v_mfma_f32_16x16x32_bf16 v[24:27], v[84:87], a[32:35], v[24:27]
    v_mfma_f32_16x16x32_bf16 v[28:31], v[84:87], a[80:83], v[28:31]
    v_mfma_f32_16x16x32_bf16 v[32:35], v[84:87], a[128:131], v[32:35]
    s_add_u32 s42, s80, 1486848
    buffer_load_dwordx4 a[176:179], v1, s[20:23], s42 offen
    v_mfma_f32_16x16x32_bf16 v[36:39], v[88:91], a[32:35], v[36:39]
    v_mfma_f32_16x16x32_bf16 v[40:43], v[88:91], a[80:83], v[40:43]
    v_mfma_f32_16x16x32_bf16 v[44:47], v[88:91], a[128:131], v[44:47]
    s_add_u32 s42, s81, 1486848
    buffer_load_dwordx4 a[224:227], v1, s[20:23], s42 offen
    v_mfma_f32_16x16x32_bf16 v[48:51], v[92:95], a[32:35], v[48:51]
    v_mfma_f32_16x16x32_bf16 v[52:55], v[92:95], a[80:83], v[52:55]
    v_mfma_f32_16x16x32_bf16 v[56:59], v[92:95], a[128:131], v[56:59]
    ds_read_b128 v[84:87], v13 offset:33792
    ds_read_b128 v[88:91], v14 offset:33792
    ds_read_b128 v[92:95], v15 offset:33792
    s_waitcnt lgkmcnt(6)
    v_mfma_f32_16x16x32_bf16 v[24:27], v[60:63], a[36:39], v[24:27]
    v_mfma_f32_16x16x32_bf16 v[28:31], v[60:63], a[84:87], v[28:31]
    v_mfma_f32_16x16x32_bf16 v[32:35], v[60:63], a[132:135], v[32:35]
    s_add_u32 s42, s80, 1487872
    buffer_load_dwordx4 a[180:183], v1, s[20:23], s42 offen
    v_mfma_f32_16x16x32_bf16 v[36:39], v[64:67], a[36:39], v[36:39]
pad50:
    s_cbranch_execz wretB
    v_mfma_f32_16x16x32_bf16 v[40:43], v[64:67], a[84:87], v[40:43]
    v_mfma_f32_16x16x32_bf16 v[44:47], v[64:67], a[132:135], v[44:47]
    s_add_u32 s42, s81, 1487872
    buffer_load_dwordx4 a[228:231], v1, s[20:23], s42 offen
    v_mfma_f32_16x16x32_bf16 v[48:51], v[68:71], a[36:39], v[48:51]
    v_mfma_f32_16x16x32_bf16 v[52:55], v[68:71], a[84:87], v[52:55]
    v_mfma_f32_16x16x32_bf16 v[56:59], v[68:71], a[132:135], v[56:59]
    s_waitcnt lgkmcnt(3)
    v_mfma_f32_16x16x32_bf16 v[24:27], v[72:75], a[40:43], v[24:27]
    v_mfma_f32_16x16x32_bf16 v[28:31], v[72:75], a[88:91], v[28:31]
    v_mfma_f32_16x16x32_bf16 v[32:35], v[72:75], a[136:139], v[32:35]
    s_add_u32 s42, s80, 1488896
    buffer_load_dwordx4 a[184:187], v1, s[20:23], s42 offen
    v_mfma_f32_16x16x32_bf16 v[36:39], v[76:79], a[40:43], v[36:39]
    v_mfma_f32_16x16x32_bf16 v[40:43], v[76:79], a[88:91], v[40:43]
    v_mfma_f32_16x16x32_bf16 v[44:47], v[76:79], a[136:139], v[44:47]
    s_add_u32 s42, s81, 1488896
    buffer_load_dwordx4 a[232:235], v1, s[20:23], s42 offen
    v_mfma_f32_16x16x32_bf16 v[48:51], v[80:83], a[40:43], v[48:51]
    v_mfma_f32_16x16x32_bf16 v[52:55], v[80:83], a[88:91], v[52:55]
    v_mfma_f32_16x16x32_bf16 v[56:59], v[80:83], a[136:139], v[56:59]
    s_waitcnt lgkmcnt(0)
    v_mfma_f32_16x16x32_bf16 v[24:27], v[84:87], a[44:47], v[24:27]
    v_mfma_f32_16x16x32_bf16 v[28:31], v[84:87], a[92:95], v[28:31]
    v_mfma_f32_16x16x32_bf16 v[32:35], v[84:87], a[140:143], v[32:35]
    s_add_u32 s42, s80, 1489920
    buffer_load_dwordx4 a[188:191], v1, s[20:23], s42 offen
    v_mfma_f32_16x16x32_bf16 v[36:39], v[88:91], a[44:47], v[36:39]
    v_mfma_f32_16x16x32_bf16 v[40:43], v[88:91], a[92:95], v[40:43]
    v_mfma_f32_16x16x32_bf16 v[44:47], v[88:91], a[140:143], v[44:47]
    s_add_u32 s42, s81, 1489920
    buffer_load_dwordx4 a[236:239], v1, s[20:23], s42 offen
    v_mfma_f32_16x16x32_bf16 v[48:51], v[92:95], a[44:47], v[48:51]
    v_mfma_f32_16x16x32_bf16 v[52:55], v[92:95], a[92:95], v[52:55]
    v_mfma_f32_16x16x32_bf16 v[56:59], v[92:95], a[140:143], v[56:59]
    s_and_b32 s83, s12, 1
    s_lshr_b32 s48, s48, 1
    s_mul_i32 s48, s48, 18432
    s_add_u32 s47, s47, s48
    s_mul_i32 s49, s49, 3072
    s_add_u32 s47, s47, s49
    s_mul_i32 s42, s83, 12288
    s_add_u32 s48, s47, s42
    s_lshl_b32 s42, s83, 9
    s_add_u32 s49, s47, s42
    s_add_u32 s49, s49, 6144
    s_lshl_b32 s42, s65, 10
    s_add_u32 s50, s48, s42
    s_add_u32 s53, s49, s42
    s_lshl_b32 s42, s66, 10
    s_add_u32 s51, s48, s42
    s_add_u32 s54, s49, s42
    s_lshl_b32 s42, s67, 10
    s_add_u32 s52, s48, s42
    s_add_u32 s55, s49, s42
    v_and_b32 v6, 1, v2
    v_lshl_add_u32 v6, v6, 10, v23
    v_fma_f32 v24, -v100, v124, v24
    v_mul_f32 v24, v24, v101
    v_fma_f32 v25, -v102, v124, v25
    v_mul_f32 v25, v25, v103
    v_fma_f32 v26, -v104, v124, v26
    v_mul_f32 v26, v26, v105
    v_fma_f32 v27, -v106, v124, v27
    v_mul_f32 v27, v27, v107
    v_cvt_pk_bf16_f32 v60, v24, v25
    v_cvt_pk_bf16_f32 v61, v26, v27
pad51:
    s_cbranch_execz wretB
    v_fma_f32 v36, -v108, v124, v36
    v_mul_f32 v36, v36, v109
    v_fma_f32 v37, -v110, v124, v37
    v_mul_f32 v37, v37, v111
    v_fma_f32 v38, -v112, v124, v38
    v_mul_f32 v38, v38, v113
    v_fma_f32 v39, -v114, v124, v39
    v_mul_f32 v39, v39, v115
    v_cvt_pk_bf16_f32 v62, v36, v37
    v_cvt_pk_bf16_f32 v63, v38, v39
    v_fma_f32 v48, -v116, v124, v48
    v_mul_f32 v48, v48, v117
    v_fma_f32 v49, -v118, v124, v49
    v_mul_f32 v49, v49, v119
    v_fma_f32 v50, -v120, v124, v50
    v_mul_f32 v50, v50, v121
    v_fma_f32 v51, -v122, v124, v51
    v_mul_f32 v51, v51, v123
    v_cvt_pk_bf16_f32 v72, v48, v49
    v_cvt_pk_bf16_f32 v73, v50, v51
    buffer_store_dwordx4 v[60:63], v1, s[20:23], s50 offen sc1
    v_fma_f32 v28, -v100, v126, v28
    v_mul_f32 v28, v28, v101
    v_fma_f32 v29, -v102, v126, v29
    v_mul_f32 v29, v29, v103
    v_fma_f32 v30, -v104, v126, v30
    v_mul_f32 v30, v30, v105
    v_fma_f32 v31, -v106, v126, v31
    v_mul_f32 v31, v31, v107
    v_cvt_pk_bf16_f32 v64, v28, v29
    v_cvt_pk_bf16_f32 v65, v30, v31
    v_fma_f32 v40, -v108, v126, v40
    v_mul_f32 v40, v40, v109
    v_fma_f32 v41, -v110, v126, v41
    v_mul_f32 v41, v41, v111
    v_fma_f32 v42, -v112, v126, v42
    v_mul_f32 v42, v42, v113
    v_fma_f32 v43, -v114, v126, v43
    v_mul_f32 v43, v43, v115
    v_cvt_pk_bf16_f32 v66, v40, v41
    v_cvt_pk_bf16_f32 v67, v42, v43
    v_fma_f32 v52, -v116, v126, v52
    v_mul_f32 v52, v52, v117
    v_fma_f32 v53, -v118, v126, v53
    v_mul_f32 v53, v53, v119
    v_fma_f32 v54, -v120, v126, v54
    v_mul_f32 v54, v54, v121
    v_fma_f32 v55, -v122, v126, v55
    v_mul_f32 v55, v55, v123
    v_cvt_pk_bf16_f32 v74, v52, v53
    v_cvt_pk_bf16_f32 v75, v54, v55
    buffer_store_dwordx4 v[64:67], v1, s[20:23], s51 offen sc1
    s_nop 1
    v_permlane16_swap_b32 v72, v74
    v_permlane16_swap_b32 v73, v75
    buffer_store_dwordx4 v[72:75], v6, s[20:23], s53 offen sc1
    v_fma_f32 v32, -v100, v128, v32
    v_mul_f32 v32, v32, v101
    v_fma_f32 v33, -v102, v128, v33
    v_mul_f32 v33, v33, v103
    v_fma_f32 v34, -v104, v128, v34
    v_mul_f32 v34, v34, v105
    v_fma_f32 v35, -v106, v128, v35
    v_mul_f32 v35, v35, v107
    v_cvt_pk_bf16_f32 v68, v32, v33
    v_cvt_pk_bf16_f32 v69, v34, v35
    v_fma_f32 v44, -v108, v128, v44
    v_mul_f32 v44, v44, v109
    v_fma_f32 v45, -v110, v128, v45
    v_mul_f32 v45, v45, v111
    v_fma_f32 v46, -v112, v128, v46
    v_mul_f32 v46, v46, v113
    v_fma_f32 v47, -v114, v128, v47
    v_mul_f32 v47, v47, v115
    v_cvt_pk_bf16_f32 v70, v44, v45
    v_cvt_pk_bf16_f32 v71, v46, v47
    v_fma_f32 v56, -v116, v128, v56
    v_mul_f32 v56, v56, v117
    v_fma_f32 v57, -v118, v128, v57
pad52:
    s_cbranch_execz wretB
    v_mul_f32 v57, v57, v119
    v_fma_f32 v58, -v120, v128, v58
    v_mul_f32 v58, v58, v121
    v_fma_f32 v59, -v122, v128, v59
    v_mul_f32 v59, v59, v123
    v_cvt_pk_bf16_f32 v76, v56, v57
    v_cvt_pk_bf16_f32 v77, v58, v59
    buffer_store_dwordx4 v[68:71], v1, s[20:23], s52 offen sc1
    v_mov_b32 v78, v76
    v_mov_b32 v79, v77
    s_nop 1
    v_permlane16_swap_b32 v76, v78
    v_permlane16_swap_b32 v77, v79
    s_mov_b64 exec, s[72:73]
    buffer_store_dwordx4 v[76:79], v23, s[20:23], s55 offen sc1
    s_mov_b64 exec, -1
p3_done:
    s_waitcnt vmcnt(0)
    s_barrier
    s_cmp_lg_u32 s3, 0
    s_cbranch_scc1 kb_s0_3917
    s_and_b32 s42, s12, 7
    s_mul_i32 s42, s42, 3
    s_lshr_b32 s43, s13, 1
    s_add_u32 s42, s42, s43
    s_and_b32 s43, s42, 7
    s_lshr_b32 s42, s42, 3
    s_lshl_b32 s42, s42, 5
    s_add_u32 s42, s42, s43
    s_lshl_b32 s42, s42, 2
    s_lshr_b32 s43, s12, 3
    s_lshl_b32 s43, s43, 4
    s_add_u32 s43, s43, s68
    s_lshl_b32 s43, s43, 9
    s_add_u32 s42, s42, s43
    s_add_u32 s42, s42, 17063936
    s_mov_b64 exec, 255
    v_mov_b32 v6, 1
    v_lshlrev_b32 v7, 10, v0
    buffer_store_dword v6, v7, s[20:23], s42 offen sc1
    s_mov_b64 exec, -1
kb_s0_3917:
p4_start:
    s_lshr_b32 s47, s12, 3
    s_lshl_b32 s47, s47, 2
    s_lshr_b32 s48, s13, 1
    s_add_u32 s47, s47, s48
    s_mul_i32 s49, s47, 73728
    s_and_b32 s50, s12, 7
    s_mul_i32 s50, s50, 3
    s_and_b32 s51, s13, 1
    s_add_u32 s50, s50, s51
    s_mul_i32 s50, s50, 3072
    s_add_u32 s50, s50, s49
    s_mul_i32 s52, s3, 18432
    s_add_u32 s52, s52, s49
    v_lshrrev_b32 v9, 3, v3
    v_mul_u32_u24 v9, 3072, v9
    v_lshl_add_u32 v9, v2, 8, v9
    v_bfe_u32 v6, v3, 2, 1
    v_lshl_add_u32 v9, v6, 7, v9
    v_and_b32 v6, 3, v3
    v_lshl_add_u32 v9, v6, 4, v9
    s_cmp_lg_u32 s3, 0
    s_cbranch_scc1 kb_w3961_d
    s_lshl_b32 s42, s12, 1
    s_lshr_b32 s43, s13, 2
    s_add_u32 s42, s42, s43
    s_lshl_b32 s42, s42, 9
    s_add_u32 s42, s42, 17063936
    v_lshrrev_b32 v7, 3, v0
    v_lshlrev_b32 v7, 7, v7
    v_and_b32 v6, 7, v0
    v_lshl_add_u32 v7, v6, 2, v7
pad53:
    s_cbranch_execz wretB
    s_mov_b32 s43, 0x40000
    s_mov_b32 exec_lo, 0xffffff
    s_mov_b32 exec_hi, 0x0
kb_w3961:
    buffer_load_dword v6, v7, s[20:23], s42 offen sc1
    s_sub_u32 s43, s43, 1
    s_cbranch_scc1 kb_w3961_x
    s_waitcnt vmcnt(0)
    v_cmp_ne_u32 vcc, 1, v6
    s_cbranch_vccnz kb_w3961
kb_w3961_x:
    s_mov_b64 exec, -1
kb_w3961_d:
    s_barrier
p4_re:
    s_add_u32 s42, s50, 6316032
    buffer_load_dwordx4 v[24:27], v1, s[20:23], s42 offen offset:0 sc1
    buffer_load_dwordx4 v[28:31], v1, s[20:23], s42 offen offset:1024 sc1
    buffer_load_dwordx4 v[32:35], v1, s[20:23], s42 offen offset:2048 sc1
    buffer_load_dwordx4 v[36:39], v1, s[20:23], s42 offen offset:3072 sc1
    s_add_u32 s42, s50, 6320128
    buffer_load_dwordx4 v[40:43], v1, s[20:23], s42 offen offset:0 sc1
    buffer_load_dwordx4 v[44:47], v1, s[20:23], s42 offen offset:1024 sc1
    s_add_u32 s42, s52, 7495680
    buffer_load_dwordx4 v[48:51], v1, s[20:23], s42 offen offset:0 sc1
    buffer_load_dwordx4 v[52:55], v1, s[20:23], s42 offen offset:1024 sc1
    buffer_load_dwordx4 v[56:59], v1, s[20:23], s42 offen offset:2048 sc1
    buffer_load_dwordx4 v[60:63], v1, s[20:23], s42 offen offset:3072 sc1
    s_add_u32 s42, s52, 7499776
    buffer_load_dwordx4 v[64:67], v1, s[20:23], s42 offen offset:0 sc1
    buffer_load_dwordx4 v[68:71], v1, s[20:23], s42 offen offset:1024 sc1
    s_add_u32 s42, s52, 7501824
    buffer_load_dwordx4 v[72:75], v9, s[20:23], s42 offen offset:0 sc1
    buffer_load_dwordx4 v[76:79], v9, s[20:23], s42 offen offset:1024 sc1
    buffer_load_dwordx4 v[80:83], v9, s[20:23], s42 offen offset:2048 sc1
    buffer_load_dwordx4 v[84:87], v9, s[20:23], s42 offen offset:64 sc1
    buffer_load_dwordx4 v[88:91], v9, s[20:23], s42 offen offset:1088 sc1
    buffer_load_dwordx4 v[92:95], v9, s[20:23], s42 offen offset:2112 sc1
    s_add_u32 s42, s52, 7507968
    buffer_load_dwordx4 v[96:99], v1, s[20:23], s42 offen offset:0 sc1
    buffer_load_dwordx4 v[100:103], v1, s[20:23], s42 offen offset:1024 sc1
    buffer_load_dwordx4 v[104:107], v1, s[20:23], s42 offen offset:2048 sc1
    buffer_load_dwordx4 v[108:111], v1, s[20:23], s42 offen offset:3072 sc1
    s_add_u32 s42, s52, 7512064
    buffer_load_dwordx4 v[112:115], v1, s[20:23], s42 offen offset:0 sc1
    buffer_load_dwordx4 v[116:119], v1, s[20:23], s42 offen offset:1024 sc1
    s_add_u32 s42, s52, 8675328
    buffer_load_dwordx4 a[0:3], v1, s[20:23], s42 offen offset:0 sc1
    buffer_load_dwordx4 a[4:7], v1, s[20:23], s42 offen offset:1024 sc1
    buffer_load_dwordx4 a[8:11], v1, s[20:23], s42 offen offset:2048 sc1
    buffer_load_dwordx4 a[12:15], v1, s[20:23], s42 offen offset:3072 sc1
    s_add_u32 s42, s52, 8679424
    buffer_load_dwordx4 a[16:19], v1, s[20:23], s42 offen offset:0 sc1
    buffer_load_dwordx4 a[20:23], v1, s[20:23], s42 offen offset:1024 sc1
    buffer_load_dwordx4 a[24:27], v1, s[20:23], s42 offen offset:2048 sc1
    buffer_load_dwordx4 a[28:31], v1, s[20:23], s42 offen offset:3072 sc1
    s_add_u32 s42, s52, 8683520
    buffer_load_dwordx4 a[32:35], v1, s[20:23], s42 offen offset:0 sc1
    buffer_load_dwordx4 a[36:39], v1, s[20:23], s42 offen offset:1024 sc1
    buffer_load_dwordx4 a[40:43], v1, s[20:23], s42 offen offset:2048 sc1
    buffer_load_dwordx4 a[44:47], v1, s[20:23], s42 offen offset:3072 sc1
    s_add_u32 s42, s52, 8687616
    buffer_load_dwordx4 a[48:51], v1, s[20:23], s42 offen offset:0 sc1
    buffer_load_dwordx4 a[52:55], v1, s[20:23], s42 offen offset:1024 sc1
    buffer_load_dwordx4 a[56:59], v1, s[20:23], s42 offen offset:2048 sc1
    buffer_load_dwordx4 a[60:63], v1, s[20:23], s42 offen offset:3072 sc1
    s_add_u32 s42, s52, 8691712
    buffer_load_dwordx4 a[64:67], v1, s[20:23], s42 offen offset:0 sc1
    buffer_load_dwordx4 a[68:71], v1, s[20:23], s42 offen offset:1024 sc1
    v_mov_b32 v168, 0x3f803f80
pad54:
    s_cbranch_execz wretB
    v_mov_b32 v169, 0x3f803f80
    v_mov_b32 v170, 0x3f803f80
    v_mov_b32 v171, 0x3f803f80
    s_mov_b32 s53, 0x3e16c740
    s_lshl_b32 s42, s3, 9
    v_add_u32 v8, s42, v5
    s_waitcnt vmcnt(33)
    v_mfma_f32_16x16x32_bf16 v[120:123], v[48:51], v[24:27], 0
    v_mfma_f32_16x16x32_bf16 v[144:147], v[48:51], v[36:39], 0
    v_mfma_f32_16x16x32_bf16 v[120:123], v[52:55], v[28:31], v[120:123]
    v_mfma_f32_16x16x32_bf16 v[144:147], v[52:55], v[40:43], v[144:147]
    v_mfma_f32_16x16x32_bf16 v[120:123], v[56:59], v[32:35], v[120:123]
    v_mfma_f32_16x16x32_bf16 v[144:147], v[56:59], v[44:47], v[144:147]
    s_waitcnt vmcnt(30)
    v_mfma_f32_16x16x32_bf16 v[124:127], v[60:63], v[24:27], 0
    v_mfma_f32_16x16x32_bf16 v[148:151], v[60:63], v[36:39], 0
    v_mfma_f32_16x16x32_bf16 v[124:127], v[64:67], v[28:31], v[124:127]
    v_mfma_f32_16x16x32_bf16 v[148:151], v[64:67], v[40:43], v[148:151]
    v_mfma_f32_16x16x32_bf16 v[124:127], v[68:71], v[32:35], v[124:127]
    v_mfma_f32_16x16x32_bf16 v[148:151], v[68:71], v[44:47], v[148:151]
    s_waitcnt vmcnt(27)
    v_mfma_f32_16x16x32_bf16 v[128:131], v[72:75], v[24:27], 0
    v_mfma_f32_16x16x32_bf16 v[152:155], v[72:75], v[36:39], 0
    v_mfma_f32_16x16x32_bf16 v[128:131], v[76:79], v[28:31], v[128:131]
    v_mfma_f32_16x16x32_bf16 v[152:155], v[76:79], v[40:43], v[152:155]
    v_mfma_f32_16x16x32_bf16 v[128:131], v[80:83], v[32:35], v[128:131]
    v_mfma_f32_16x16x32_bf16 v[152:155], v[80:83], v[44:47], v[152:155]
    s_waitcnt vmcnt(24)
    v_mfma_f32_16x16x32_bf16 v[132:135], v[84:87], v[24:27], 0
    v_mfma_f32_16x16x32_bf16 v[156:159], v[84:87], v[36:39], 0
    v_mfma_f32_16x16x32_bf16 v[132:135], v[88:91], v[28:31], v[132:135]
    v_mfma_f32_16x16x32_bf16 v[156:159], v[88:91], v[40:43], v[156:159]
    v_mfma_f32_16x16x32_bf16 v[132:135], v[92:95], v[32:35], v[132:135]
    v_mfma_f32_16x16x32_bf16 v[156:159], v[92:95], v[44:47], v[156:159]
    s_waitcnt vmcnt(21)
    v_mfma_f32_16x16x32_bf16 v[136:139], v[96:99], v[24:27], 0
    v_mfma_f32_16x16x32_bf16 v[160:163], v[96:99], v[36:39], 0
    v_mfma_f32_16x16x32_bf16 v[136:139], v[100:103], v[28:31], v[136:139]
    v_mfma_f32_16x16x32_bf16 v[160:163], v[100:103], v[40:43], v[160:163]
    v_mfma_f32_16x16x32_bf16 v[136:139], v[104:107], v[32:35], v[136:139]
    v_mfma_f32_16x16x32_bf16 v[160:163], v[104:107], v[44:47], v[160:163]
    s_waitcnt vmcnt(18)
    v_mfma_f32_16x16x32_bf16 v[140:143], v[108:111], v[24:27], 0
    v_mfma_f32_16x16x32_bf16 v[164:167], v[108:111], v[36:39], 0
    v_mfma_f32_16x16x32_bf16 v[140:143], v[112:115], v[28:31], v[140:143]
    v_mfma_f32_16x16x32_bf16 v[164:167], v[112:115], v[40:43], v[164:167]
    v_mfma_f32_16x16x32_bf16 v[140:143], v[116:119], v[32:35], v[140:143]
    v_mfma_f32_16x16x32_bf16 v[164:167], v[116:119], v[44:47], v[164:167]
    s_add_u32 s42, s77, 1183744
    buffer_load_dwordx4 v[188:191], v1, s[20:23], s42 offen offset:0
    buffer_load_dwordx4 v[192:195], v1, s[20:23], s42 offen offset:1024
    buffer_load_dwordx4 v[196:199], v1, s[20:23], s42 offen offset:2048
    s_add_u32 s42, s78, 1183744
    buffer_load_dwordx4 v[200:203], v1, s[20:23], s42 offen offset:0
    buffer_load_dwordx4 v[204:207], v1, s[20:23], s42 offen offset:1024
    buffer_load_dwordx4 v[208:211], v1, s[20:23], s42 offen offset:2048
    s_add_u32 s42, s79, 1183744
    buffer_load_dwordx4 v[212:215], v1, s[20:23], s42 offen offset:0
    buffer_load_dwordx4 v[216:219], v1, s[20:23], s42 offen offset:1024
    buffer_load_dwordx4 v[220:223], v1, s[20:23], s42 offen offset:2048
    s_lshl_b32 s77, s77, 2
    s_lshl_b32 s78, s78, 2
    s_lshl_b32 s79, s79, 2
    v_max3_f32 v10, v120, v121, v122
    v_max3_f32 v10, v10, v123, v124
    v_max3_f32 v10, v10, v125, v126
    v_max3_f32 v10, v10, v127, v128
pad55:
    s_cbranch_execz wretB
    v_max3_f32 v10, v10, v129, v130
    v_max3_f32 v10, v10, v131, v132
    v_max3_f32 v10, v10, v133, v134
    v_max3_f32 v10, v10, v135, v136
    v_max3_f32 v10, v10, v137, v138
    v_max3_f32 v10, v10, v139, v140
    v_max3_f32 v10, v10, v141, v142
    v_max_f32 v10, v10, v143
    v_mov_b32 v6, v10
    s_nop 1
    v_permlane16_swap_b32 v10, v6
    s_nop 1
    v_max_f32 v10, v10, v6
    v_mov_b32 v6, v10
    s_nop 1
    v_permlane32_swap_b32 v10, v6
    s_nop 1
    v_max_f32 v10, v10, v6
    ds_write_b32 v8, v10 offset:0
    v_max3_f32 v11, v144, v145, v146
    v_max3_f32 v11, v11, v147, v148
    v_max3_f32 v11, v11, v149, v150
    v_max3_f32 v11, v11, v151, v152
    v_max3_f32 v11, v11, v153, v154
    v_max3_f32 v11, v11, v155, v156
    v_max3_f32 v11, v11, v157, v158
    v_max3_f32 v11, v11, v159, v160
    v_max3_f32 v11, v11, v161, v162
    v_max3_f32 v11, v11, v163, v164
    v_max3_f32 v11, v11, v165, v166
    v_max_f32 v11, v11, v167
    v_mov_b32 v6, v11
    s_nop 1
    v_permlane16_swap_b32 v11, v6
    s_nop 1
    v_max_f32 v11, v11, v6
    v_mov_b32 v6, v11
    s_nop 1
    v_permlane32_swap_b32 v11, v6
    s_nop 1
    v_max_f32 v11, v11, v6
    ds_write_b32 v8, v11 offset:256
    s_waitcnt lgkmcnt(0)
    s_barrier
    ds_read_b32 v48, v5 offset:0
    ds_read_b32 v49, v5 offset:512
    ds_read_b32 v50, v5 offset:1024
    ds_read_b32 v51, v5 offset:1536
    ds_read_b32 v52, v5 offset:256
    ds_read_b32 v53, v5 offset:768
    ds_read_b32 v54, v5 offset:1280
    ds_read_b32 v55, v5 offset:1792
    s_waitcnt vmcnt(9)
    s_cmp_eq_u32 s3, 1
    s_cbranch_scc1 on4162
    v_mov_b32 v112, -1
    v_mov_b32 v113, -1
    v_mov_b32 v114, -1
    v_mov_b32 v115, -1
    s_mul_i32 s32, s14, 49152
    s_mul_i32 s33, s13, 6144
    s_add_u32 s32, s32, s33
    s_max_u32 s33, s3, 1
    s_sub_u32 s33, s33, 1
    s_mul_i32 s33, s33, 49152
    s_add_u32 s32, s32, s33
    s_add_u32 s42, s32, 12312576
    buffer_store_dwordx4 v[112:115], v1, s[20:23], s42 offen offset:0 sc1
    buffer_store_dwordx4 v[112:115], v1, s[20:23], s42 offen offset:1024 sc1
    buffer_store_dwordx4 v[112:115], v1, s[20:23], s42 offen offset:2048 sc1
    buffer_store_dwordx4 v[112:115], v1, s[20:23], s42 offen offset:3072 sc1
    s_add_u32 s42, s32, 12316672
    buffer_store_dwordx4 v[112:115], v1, s[20:23], s42 offen offset:0 sc1
    buffer_store_dwordx4 v[112:115], v1, s[20:23], s42 offen offset:1024 sc1
on4162:
    s_cmp_lg_u32 s3, 0
    s_cbranch_scc1 on4184
    v_mov_b32 v112, -1
    v_mov_b32 v113, -1
    v_mov_b32 v114, -1
pad56:
    s_cbranch_execz wretB
    v_mov_b32 v115, -1
    s_mul_i32 s32, s3, 12288
    s_sub_u32 s33, s38, s32
    s_sub_u32 s34, s39, s32
    s_lshl_b32 s35, s14, 10
    s_lshl_b32 s36, s13, 3
    s_add_u32 s35, s35, s36
    v_lshlrev_b32 v6, 6, v0
    s_add_u32 s42, s33, 11034624
    buffer_store_dwordx4 v[112:115], v1, s[20:23], s42 offen offset:0 sc1
    s_add_u32 s42, s33, 11046912
    buffer_store_dwordx4 v[112:115], v1, s[20:23], s42 offen offset:0 sc1
    s_add_u32 s42, s33, 11059200
    buffer_store_dwordx4 v[112:115], v1, s[20:23], s42 offen offset:0 sc1
    s_mov_b32 exec_hi, 0xffff
    s_add_u32 s42, s35, 12214272
    buffer_store_dwordx2 v[112:113], v6, s[20:23], s42 offen sc1
    s_mov_b32 exec_hi, 0
    s_add_u32 s42, s34, 11034624
    buffer_store_dwordx4 v[112:115], v1, s[20:23], s42 offen offset:0 sc1
    s_add_u32 s42, s34, 11046912
    buffer_store_dwordx4 v[112:115], v1, s[20:23], s42 offen offset:0 sc1
    s_add_u32 s42, s34, 11059200
    buffer_store_dwordx4 v[112:115], v1, s[20:23], s42 offen offset:0 sc1
    s_mov_b64 exec, -1
on4184:
    s_waitcnt lgkmcnt(0)
    v_max3_f32 v10, v48, v49, v50
    v_max_f32 v10, v10, v51
    v_mul_f32 v10, s53, v10
    v_max3_f32 v11, v52, v53, v54
    v_max_f32 v11, v11, v55
    v_mul_f32 v11, s53, v11
    v_fma_f32 v120, v120, s53, -v10
    v_fma_f32 v121, v121, s53, -v10
    v_fma_f32 v122, v122, s53, -v10
    v_fma_f32 v123, v123, s53, -v10
    v_fma_f32 v124, v124, s53, -v10
    v_fma_f32 v125, v125, s53, -v10
    v_fma_f32 v126, v126, s53, -v10
    v_fma_f32 v127, v127, s53, -v10
    v_fma_f32 v128, v128, s53, -v10
    v_fma_f32 v129, v129, s53, -v10
    v_fma_f32 v130, v130, s53, -v10
    v_fma_f32 v131, v131, s53, -v10
    v_fma_f32 v132, v132, s53, -v10
    v_fma_f32 v133, v133, s53, -v10
    v_fma_f32 v134, v134, s53, -v10
    v_fma_f32 v135, v135, s53, -v10
    v_fma_f32 v136, v136, s53, -v10
    v_fma_f32 v137, v137, s53, -v10
    v_fma_f32 v138, v138, s53, -v10
    v_fma_f32 v139, v139, s53, -v10
    v_fma_f32 v140, v140, s53, -v10
    v_fma_f32 v141, v141, s53, -v10
    v_fma_f32 v142, v142, s53, -v10
    v_fma_f32 v143, v143, s53, -v10
    v_exp_f32 v120, v120
    v_exp_f32 v121, v121
    v_exp_f32 v122, v122
    v_exp_f32 v123, v123
    v_exp_f32 v124, v124
    v_exp_f32 v125, v125
    v_exp_f32 v126, v126
    v_exp_f32 v127, v127
    v_exp_f32 v128, v128
    v_exp_f32 v129, v129
    v_exp_f32 v130, v130
    v_exp_f32 v131, v131
    v_exp_f32 v132, v132
    v_exp_f32 v133, v133
    v_exp_f32 v134, v134
    v_exp_f32 v135, v135
    v_exp_f32 v136, v136
    v_exp_f32 v137, v137
    v_exp_f32 v138, v138
    v_exp_f32 v139, v139
    v_exp_f32 v140, v140
    v_exp_f32 v141, v141
pad57:
    s_cbranch_execz wretB
    v_exp_f32 v142, v142
    v_exp_f32 v143, v143
    s_nop 0
    v_cvt_pk_bf16_f32 v24, v120, v121
    v_cvt_pk_bf16_f32 v25, v122, v123
    v_cvt_pk_bf16_f32 v26, v124, v125
    v_cvt_pk_bf16_f32 v27, v126, v127
    v_cvt_pk_bf16_f32 v28, v128, v129
    v_cvt_pk_bf16_f32 v29, v130, v131
    v_cvt_pk_bf16_f32 v30, v132, v133
    v_cvt_pk_bf16_f32 v31, v134, v135
    v_cvt_pk_bf16_f32 v32, v136, v137
    v_cvt_pk_bf16_f32 v33, v138, v139
    v_cvt_pk_bf16_f32 v34, v140, v141
    v_cvt_pk_bf16_f32 v35, v142, v143
    v_fma_f32 v144, v144, s53, -v11
    v_fma_f32 v145, v145, s53, -v11
    v_fma_f32 v146, v146, s53, -v11
    v_fma_f32 v147, v147, s53, -v11
    v_fma_f32 v148, v148, s53, -v11
    v_fma_f32 v149, v149, s53, -v11
    v_fma_f32 v150, v150, s53, -v11
    v_fma_f32 v151, v151, s53, -v11
    v_fma_f32 v152, v152, s53, -v11
    v_fma_f32 v153, v153, s53, -v11
    v_fma_f32 v154, v154, s53, -v11
    v_fma_f32 v155, v155, s53, -v11
    v_fma_f32 v156, v156, s53, -v11
    v_fma_f32 v157, v157, s53, -v11
    v_fma_f32 v158, v158, s53, -v11
    v_fma_f32 v159, v159, s53, -v11
    v_fma_f32 v160, v160, s53, -v11
    v_fma_f32 v161, v161, s53, -v11
    v_fma_f32 v162, v162, s53, -v11
    v_fma_f32 v163, v163, s53, -v11
    v_fma_f32 v164, v164, s53, -v11
    v_fma_f32 v165, v165, s53, -v11
    v_fma_f32 v166, v166, s53, -v11
    v_fma_f32 v167, v167, s53, -v11
    v_exp_f32 v144, v144
    v_exp_f32 v145, v145
    v_exp_f32 v146, v146
    v_exp_f32 v147, v147
    v_exp_f32 v148, v148
    v_exp_f32 v149, v149
    v_exp_f32 v150, v150
    v_exp_f32 v151, v151
    v_exp_f32 v152, v152
    v_exp_f32 v153, v153
    v_exp_f32 v154, v154
    v_exp_f32 v155, v155
    v_exp_f32 v156, v156
    v_exp_f32 v157, v157
    v_exp_f32 v158, v158
    v_exp_f32 v159, v159
    v_exp_f32 v160, v160
    v_exp_f32 v161, v161
    v_exp_f32 v162, v162
    v_exp_f32 v163, v163
    v_exp_f32 v164, v164
    v_exp_f32 v165, v165
    v_exp_f32 v166, v166
    v_exp_f32 v167, v167
    s_nop 0
    v_cvt_pk_bf16_f32 v36, v144, v145
    v_cvt_pk_bf16_f32 v37, v146, v147
    v_cvt_pk_bf16_f32 v38, v148, v149
    v_cvt_pk_bf16_f32 v39, v150, v151
    v_cvt_pk_bf16_f32 v40, v152, v153
    v_cvt_pk_bf16_f32 v41, v154, v155
    v_cvt_pk_bf16_f32 v42, v156, v157
    v_cvt_pk_bf16_f32 v43, v158, v159
    v_cvt_pk_bf16_f32 v44, v160, v161
    v_cvt_pk_bf16_f32 v45, v162, v163
    v_cvt_pk_bf16_f32 v46, v164, v165
    v_cvt_pk_bf16_f32 v47, v166, v167
    s_nop 1
p4_v:
    v_mfma_f32_16x16x32_bf16 v[48:51], a[0:3], v[24:27], 0
pad58:
    s_cbranch_execz wretB
    v_mfma_f32_16x16x32_bf16 v[52:55], a[4:7], v[24:27], 0
    v_mfma_f32_16x16x32_bf16 v[56:59], a[8:11], v[24:27], 0
    v_mfma_f32_16x16x32_bf16 v[60:63], a[12:15], v[24:27], 0
    v_mfma_f32_16x16x32_bf16 v[64:67], a[16:19], v[24:27], 0
    v_mfma_f32_16x16x32_bf16 v[68:71], a[20:23], v[24:27], 0
    v_mfma_f32_16x16x32_bf16 v[96:99], v[168:171], v[24:27], 0
    v_mfma_f32_16x16x32_bf16 v[72:75], a[0:3], v[36:39], 0
    v_mfma_f32_16x16x32_bf16 v[76:79], a[4:7], v[36:39], 0
    v_mfma_f32_16x16x32_bf16 v[80:83], a[8:11], v[36:39], 0
    v_mfma_f32_16x16x32_bf16 v[84:87], a[12:15], v[36:39], 0
    v_mfma_f32_16x16x32_bf16 v[88:91], a[16:19], v[36:39], 0
    v_mfma_f32_16x16x32_bf16 v[92:95], a[20:23], v[36:39], 0
    v_mfma_f32_16x16x32_bf16 v[100:103], v[168:171], v[36:39], 0
    v_mfma_f32_16x16x32_bf16 v[48:51], a[24:27], v[28:31], v[48:51]
    v_mfma_f32_16x16x32_bf16 v[52:55], a[28:31], v[28:31], v[52:55]
    v_mfma_f32_16x16x32_bf16 v[56:59], a[32:35], v[28:31], v[56:59]
    v_mfma_f32_16x16x32_bf16 v[60:63], a[36:39], v[28:31], v[60:63]
    v_mfma_f32_16x16x32_bf16 v[64:67], a[40:43], v[28:31], v[64:67]
    v_mfma_f32_16x16x32_bf16 v[68:71], a[44:47], v[28:31], v[68:71]
    v_mfma_f32_16x16x32_bf16 v[96:99], v[168:171], v[28:31], v[96:99]
    v_mfma_f32_16x16x32_bf16 v[72:75], a[24:27], v[40:43], v[72:75]
    v_mfma_f32_16x16x32_bf16 v[76:79], a[28:31], v[40:43], v[76:79]
    v_mfma_f32_16x16x32_bf16 v[80:83], a[32:35], v[40:43], v[80:83]
    v_mfma_f32_16x16x32_bf16 v[84:87], a[36:39], v[40:43], v[84:87]
    v_mfma_f32_16x16x32_bf16 v[88:91], a[40:43], v[40:43], v[88:91]
    v_mfma_f32_16x16x32_bf16 v[92:95], a[44:47], v[40:43], v[92:95]
    v_mfma_f32_16x16x32_bf16 v[100:103], v[168:171], v[40:43], v[100:103]
    v_mfma_f32_16x16x32_bf16 v[48:51], a[48:51], v[32:35], v[48:51]
    v_mfma_f32_16x16x32_bf16 v[52:55], a[52:55], v[32:35], v[52:55]
    v_mfma_f32_16x16x32_bf16 v[56:59], a[56:59], v[32:35], v[56:59]
    v_mfma_f32_16x16x32_bf16 v[60:63], a[60:63], v[32:35], v[60:63]
    v_mfma_f32_16x16x32_bf16 v[64:67], a[64:67], v[32:35], v[64:67]
    v_mfma_f32_16x16x32_bf16 v[68:71], a[68:71], v[32:35], v[68:71]
    v_mfma_f32_16x16x32_bf16 v[96:99], v[168:171], v[32:35], v[96:99]
    v_mfma_f32_16x16x32_bf16 v[72:75], a[48:51], v[44:47], v[72:75]
    v_mfma_f32_16x16x32_bf16 v[76:79], a[52:55], v[44:47], v[76:79]
    v_mfma_f32_16x16x32_bf16 v[80:83], a[56:59], v[44:47], v[80:83]
    v_mfma_f32_16x16x32_bf16 v[84:87], a[60:63], v[44:47], v[84:87]
    v_mfma_f32_16x16x32_bf16 v[88:91], a[64:67], v[44:47], v[88:91]
    v_mfma_f32_16x16x32_bf16 v[92:95], a[68:71], v[44:47], v[92:95]
    v_mfma_f32_16x16x32_bf16 v[100:103], v[168:171], v[44:47], v[100:103]
    s_cmp_lg_u32 s3, 1
    s_cbranch_scc1 on4388
    s_add_u32 s42, s82, 1478656
    buffer_load_dwordx4 a[240:243], v1, s[20:23], s42 offen offset:0
    buffer_load_dwordx4 a[244:247], v1, s[20:23], s42 offen offset:1024
    buffer_load_dwordx4 a[248:251], v1, s[20:23], s42 offen offset:2048
    buffer_load_dwordx4 a[252:255], v1, s[20:23], s42 offen offset:3072
    s_add_u32 s42, s82, 1482752
    buffer_load_dwordx4 v[224:227], v1, s[20:23], s42 offen offset:0
    buffer_load_dwordx4 v[228:231], v1, s[20:23], s42 offen offset:1024
    buffer_load_dwordx4 v[232:235], v1, s[20:23], s42 offen offset:2048
    buffer_load_dwordx4 v[236:239], v1, s[20:23], s42 offen offset:3072
    s_add_u32 s42, s82, 1486848
    buffer_load_dwordx4 v[240:243], v1, s[20:23], s42 offen offset:0
    buffer_load_dwordx4 v[244:247], v1, s[20:23], s42 offen offset:1024
    buffer_load_dwordx4 v[248:251], v1, s[20:23], s42 offen offset:2048
    buffer_load_dwordx4 v[252:255], v1, s[20:23], s42 offen offset:3072
on4388:
    s_mul_i32 s42, s3, 12288
    s_add_u32 s42, s42, 4096
    v_add_u32 v6, s42, v1
    s_mul_i32 s42, s3, 3072
    s_add_u32 s42, s42, 4096
    s_lshl_b32 s43, s65, 10
    s_add_u32 s43, s43, s42
pad59:
    s_cbranch_execz wretB
    v_add_u32 v7, s43, v1
    s_lshl_b32 s43, s67, 10
    s_add_u32 s43, s43, s42
    v_add_u32 v10, s43, v1
    s_lshr_b32 s54, s3, 1
    s_lshl_b32 s42, s54, 8
    v_add_u32 v9, s42, v5
    s_nop 2
    ds_write_b128 v6, v[48:51] offset:0
    ds_write_b128 v6, v[52:55] offset:1024
    ds_write_b128 v6, v[56:59] offset:2048
    ds_write_b128 v6, v[60:63] offset:3072
    ds_write_b128 v6, v[64:67] offset:4096
    ds_write_b128 v6, v[68:71] offset:5120
    ds_write_b128 v6, v[72:75] offset:6144
    ds_write_b128 v6, v[76:79] offset:7168
    ds_write_b128 v6, v[80:83] offset:8192
    ds_write_b128 v6, v[84:87] offset:9216
    ds_write_b128 v6, v[88:91] offset:10240
    ds_write_b128 v6, v[92:95] offset:11264
    ds_write_b32 v8, v96 offset:2048
    ds_write_b32 v8, v100 offset:2304
    s_add_u32 s55, s14, s51
    s_add_u32 s55, s55, s54
    s_mul_i32 s55, s55, 12
    s_mul_i32 s42, s48, 3
    s_add_u32 s55, s55, s42
    s_lshl_b32 s55, s55, 10
    s_add_u32 s55, s55, 9854976
    s_add_u32 s56, s55, s70
    s_add_u32 s57, s55, s71
    s_waitcnt lgkmcnt(0)
    s_barrier
    s_cmp_gt_u32 s51, s54
    s_cbranch_scc1 p4_fin
    ds_read_b32 v12, v9 offset:2048
    ds_read_b32 v13, v9 offset:2560
    ds_read_b32 v14, v9 offset:3072
    ds_read_b32 v15, v9 offset:3584
    ds_read_b128 v[104:107], v7 offset:0
    ds_read_b128 v[108:111], v7 offset:1024
    ds_read_b128 v[112:115], v10 offset:0
    ds_read_b128 v[116:119], v7 offset:12288
    ds_read_b128 v[120:123], v7 offset:13312
    ds_read_b128 v[124:127], v10 offset:12288
    ds_read_b128 v[128:131], v7 offset:24576
    ds_read_b128 v[132:135], v7 offset:25600
    ds_read_b128 v[136:139], v10 offset:24576
    ds_read_b128 v[140:143], v7 offset:36864
    ds_read_b128 v[144:147], v7 offset:37888
    ds_read_b128 v[148:151], v10 offset:36864
    s_waitcnt lgkmcnt(12)
    v_add_f32 v12, v12, v13
    v_add_f32 v14, v14, v15
    v_add_f32 v12, v12, v14
    v_rcp_f32 v12, v12
    s_nop 0
    v_mov_b32 v13, v12
    s_waitcnt lgkmcnt(0)
    v_pk_add_f32 v[104:105], v[104:105], v[116:117]
    v_pk_add_f32 v[128:129], v[128:129], v[140:141]
    v_pk_add_f32 v[106:107], v[106:107], v[118:119]
    v_pk_add_f32 v[130:131], v[130:131], v[142:143]
    v_pk_add_f32 v[108:109], v[108:109], v[120:121]
    v_pk_add_f32 v[132:133], v[132:133], v[144:145]
    v_pk_add_f32 v[110:111], v[110:111], v[122:123]
    v_pk_add_f32 v[134:135], v[134:135], v[146:147]
    v_pk_add_f32 v[112:113], v[112:113], v[124:125]
    v_pk_add_f32 v[136:137], v[136:137], v[148:149]
    v_pk_add_f32 v[114:115], v[114:115], v[126:127]
    v_pk_add_f32 v[138:139], v[138:139], v[150:151]
pad60:
    s_cbranch_execz wretB
    v_pk_add_f32 v[104:105], v[104:105], v[128:129]
    v_pk_mul_f32 v[104:105], v[104:105], v[12:13]
    v_cvt_pk_bf16_f32 v24, v104, v105
    v_pk_add_f32 v[106:107], v[106:107], v[130:131]
    v_pk_mul_f32 v[106:107], v[106:107], v[12:13]
    v_cvt_pk_bf16_f32 v25, v106, v107
    v_pk_add_f32 v[108:109], v[108:109], v[132:133]
    v_pk_mul_f32 v[108:109], v[108:109], v[12:13]
    v_cvt_pk_bf16_f32 v26, v108, v109
    v_pk_add_f32 v[110:111], v[110:111], v[134:135]
    v_pk_mul_f32 v[110:111], v[110:111], v[12:13]
    v_cvt_pk_bf16_f32 v27, v110, v111
    v_pk_add_f32 v[112:113], v[112:113], v[136:137]
    v_pk_mul_f32 v[112:113], v[112:113], v[12:13]
    v_cvt_pk_bf16_f32 v28, v112, v113
    v_pk_add_f32 v[114:115], v[114:115], v[138:139]
    v_pk_mul_f32 v[114:115], v[114:115], v[12:13]
    v_cvt_pk_bf16_f32 v29, v114, v115
    buffer_store_dwordx4 v[24:27], v1, s[20:23], s56 offen sc1
    v_mov_b32 v30, v28
    v_mov_b32 v31, v29
    s_nop 1
    v_permlane16_swap_b32 v28, v30
    v_permlane16_swap_b32 v29, v31
    s_mov_b64 exec, s[72:73]
    buffer_store_dwordx4 v[28:31], v23, s[20:23], s57 offen sc1
    s_mov_b64 exec, -1
p4_fin:
    s_barrier
    s_cmp_lg_u32 s3, 0
    s_cbranch_scc1 kb_s0_4513
    s_add_u32 s42, s46, 4096
    s_mov_b64 exec, 1
    v_mov_b32 v6, 1
    v_lshlrev_b32 v7, 8, v0
    buffer_store_dword v6, v7, s[20:23], s42 offen sc1
    s_mov_b64 exec, -1
kb_s0_4513:
    s_cmp_eq_u32 s3, 1
    s_cbranch_scc1 on4522
    s_add_u32 s42, s82, 1478656
    buffer_load_dwordx4 a[240:243], v1, s[20:23], s42 offen offset:0
    buffer_load_dwordx4 a[244:247], v1, s[20:23], s42 offen offset:1024
    buffer_load_dwordx4 a[248:251], v1, s[20:23], s42 offen offset:2048
    buffer_load_dwordx4 a[252:255], v1, s[20:23], s42 offen offset:3072
    s_add_u32 s42, s82, 1482752
    buffer_load_dwordx4 v[224:227], v1, s[20:23], s42 offen offset:0
    buffer_load_dwordx4 v[228:231], v1, s[20:23], s42 offen offset:1024
    buffer_load_dwordx4 v[232:235], v1, s[20:23], s42 offen offset:2048
    buffer_load_dwordx4 v[236:239], v1, s[20:23], s42 offen offset:3072
    s_add_u32 s42, s82, 1486848
    buffer_load_dwordx4 v[240:243], v1, s[20:23], s42 offen offset:0
    buffer_load_dwordx4 v[244:247], v1, s[20:23], s42 offen offset:1024
    buffer_load_dwordx4 v[248:251], v1, s[20:23], s42 offen offset:2048
    buffer_load_dwordx4 v[252:255], v1, s[20:23], s42 offen offset:3072
on4522:
    s_cmp_lg_u32 s3, 1
    s_cbranch_scc1 kb_w4540_d
    s_add_u32 s42, s45, 4096
    v_lshrrev_b32 v7, 3, v0
    v_lshlrev_b32 v7, 7, v7
    v_and_b32 v6, 7, v0
    v_lshl_add_u32 v7, v6, 2, v7
    s_mov_b32 s43, 0x40000
    s_mov_b32 exec_lo, 0xff
    s_mov_b32 exec_hi, 0x0
kb_w4540:
    buffer_load_dword v6, v5, s[20:23], s42 offen sc1
    s_sub_u32 s43, s43, 1
    s_cbranch_scc1 kb_w4540_x
    s_waitcnt vmcnt(0)
    v_cmp_ne_u32 vcc, 1, v6
    s_cbranch_vccnz kb_w4540
kb_w4540_x:
    s_mov_b64 exec, -1
kb_w4540_d:
    s_barrier
p5_re:
    s_add_u32 s32, s16, 9854976
pad61:
    s_cbranch_execz wretB
    s_add_u32 s33, s16, 9867264
    s_add_u32 s34, s16, 9879552
    buffer_load_dwordx4 v[60:63], v1, s[20:23], s32 offen offset:0 sc1
    buffer_load_dwordx4 v[64:67], v1, s[20:23], s33 offen offset:0 sc1
    buffer_load_dwordx4 v[68:71], v1, s[20:23], s34 offen offset:0 sc1
    buffer_load_dwordx4 v[72:75], v1, s[20:23], s32 offen offset:1024 sc1
    buffer_load_dwordx4 v[76:79], v1, s[20:23], s33 offen offset:1024 sc1
    buffer_load_dwordx4 v[80:83], v1, s[20:23], s34 offen offset:1024 sc1
    buffer_load_dwordx4 v[84:87], v1, s[20:23], s32 offen offset:2048 sc1
    buffer_load_dwordx4 v[88:91], v1, s[20:23], s33 offen offset:2048 sc1
    buffer_load_dwordx4 v[92:95], v1, s[20:23], s34 offen offset:2048 sc1
    s_waitcnt vmcnt(6)
    v_mfma_f32_16x16x32_bf16 v[24:27], v[188:191], v[60:63], 0
    v_mfma_f32_16x16x32_bf16 v[28:31], v[200:203], v[60:63], 0
    v_mfma_f32_16x16x32_bf16 v[32:35], v[212:215], v[60:63], 0
    v_mfma_f32_16x16x32_bf16 v[36:39], v[188:191], v[64:67], 0
    v_mfma_f32_16x16x32_bf16 v[40:43], v[200:203], v[64:67], 0
    v_mfma_f32_16x16x32_bf16 v[44:47], v[212:215], v[64:67], 0
    v_mfma_f32_16x16x32_bf16 v[48:51], v[188:191], v[68:71], 0
    v_mfma_f32_16x16x32_bf16 v[52:55], v[200:203], v[68:71], 0
    v_mfma_f32_16x16x32_bf16 v[56:59], v[212:215], v[68:71], 0
    v_max_u32 v8, v60, v64
    v_max_u32 v8, v8, v68
    s_waitcnt vmcnt(3)
    v_mfma_f32_16x16x32_bf16 v[24:27], v[192:195], v[72:75], v[24:27]
    v_mfma_f32_16x16x32_bf16 v[28:31], v[204:207], v[72:75], v[28:31]
    v_mfma_f32_16x16x32_bf16 v[32:35], v[216:219], v[72:75], v[32:35]
    v_mfma_f32_16x16x32_bf16 v[36:39], v[192:195], v[76:79], v[36:39]
    v_mfma_f32_16x16x32_bf16 v[40:43], v[204:207], v[76:79], v[40:43]
    v_mfma_f32_16x16x32_bf16 v[44:47], v[216:219], v[76:79], v[44:47]
    v_mfma_f32_16x16x32_bf16 v[48:51], v[192:195], v[80:83], v[48:51]
    v_mfma_f32_16x16x32_bf16 v[52:55], v[204:207], v[80:83], v[52:55]
    v_mfma_f32_16x16x32_bf16 v[56:59], v[216:219], v[80:83], v[56:59]
    v_max3_u32 v8, v8, v72, v76
    v_max_u32 v8, v8, v80
    s_waitcnt vmcnt(0)
    v_mfma_f32_16x16x32_bf16 v[24:27], v[196:199], v[84:87], v[24:27]
    v_mfma_f32_16x16x32_bf16 v[28:31], v[208:211], v[84:87], v[28:31]
    v_mfma_f32_16x16x32_bf16 v[32:35], v[220:223], v[84:87], v[32:35]
    v_mfma_f32_16x16x32_bf16 v[36:39], v[196:199], v[88:91], v[36:39]
    v_mfma_f32_16x16x32_bf16 v[40:43], v[208:211], v[88:91], v[40:43]
    v_mfma_f32_16x16x32_bf16 v[44:47], v[220:223], v[88:91], v[44:47]
    v_mfma_f32_16x16x32_bf16 v[48:51], v[196:199], v[92:95], v[48:51]
    v_mfma_f32_16x16x32_bf16 v[52:55], v[208:211], v[92:95], v[52:55]
    v_mfma_f32_16x16x32_bf16 v[56:59], v[220:223], v[92:95], v[56:59]
    v_max3_u32 v8, v8, v84, v88
    v_max_u32 v8, v8, v92
    v_cmp_eq_u32 vcc, -1, v8
    s_cbranch_vccz p5_re_ok
    s_sub_u32 s40, s40, 1
    s_cbranch_scc0 p5_re
    s_mov_b32 s40, 0
p5_re_ok:
    s_mul_i32 s42, s3, 9216
    s_add_u32 s42, s42, 36864
    v_add_u32 v6, s42, v1
    s_mul_i32 s42, s3, 3072
    s_add_u32 s42, s42, 36864
    v_add_u32 v7, s42, v1
    s_nop 2
    ds_write_b128 v6, v[24:27] offset:0
    ds_write_b128 v6, v[28:31] offset:1024
    ds_write_b128 v6, v[32:35] offset:2048
    ds_write_b128 v6, v[36:39] offset:3072
    ds_write_b128 v6, v[40:43] offset:4096
    ds_write_b128 v6, v[44:47] offset:5120
    ds_write_b128 v6, v[48:51] offset:6144
    ds_write_b128 v6, v[52:55] offset:7168
    ds_write_b128 v6, v[56:59] offset:8192
    s_waitcnt lgkmcnt(0)
    s_barrier
    s_cmp_eq_u32 s3, 3
    s_cbranch_scc1 p5_fin
pad62:
    s_cbranch_execz wretB
    ds_read_b128 v[60:63], v7 offset:0
    ds_read_b128 v[64:67], v7 offset:1024
    ds_read_b128 v[68:71], v7 offset:2048
    ds_read_b128 v[72:75], v7 offset:9216
    ds_read_b128 v[76:79], v7 offset:10240
    ds_read_b128 v[80:83], v7 offset:11264
    ds_read_b128 v[84:87], v7 offset:18432
    ds_read_b128 v[88:91], v7 offset:19456
    ds_read_b128 v[92:95], v7 offset:20480
    ds_read_b128 v[96:99], v7 offset:27648
    ds_read_b128 v[100:103], v7 offset:28672
    ds_read_b128 v[104:107], v7 offset:29696
    v_lshlrev_b32 v24, 16, v16
    v_and_b32 v25, 0xffff0000, v16
    v_lshlrev_b32 v26, 16, v17
    v_and_b32 v27, 0xffff0000, v17
    v_lshlrev_b32 v28, 16, v18
    v_and_b32 v29, 0xffff0000, v18
    v_lshlrev_b32 v30, 16, v19
    v_and_b32 v31, 0xffff0000, v19
    v_lshlrev_b32 v32, 16, v20
    v_and_b32 v33, 0xffff0000, v20
    v_lshlrev_b32 v34, 16, v21
    v_and_b32 v35, 0xffff0000, v21
    s_waitcnt lgkmcnt(9)
    v_pk_add_f32 v[24:25], v[24:25], v[60:61]
    v_pk_add_f32 v[26:27], v[26:27], v[62:63]
    v_pk_add_f32 v[28:29], v[28:29], v[64:65]
    v_pk_add_f32 v[30:31], v[30:31], v[66:67]
    v_pk_add_f32 v[32:33], v[32:33], v[68:69]
    v_pk_add_f32 v[34:35], v[34:35], v[70:71]
    s_waitcnt lgkmcnt(6)
    v_pk_add_f32 v[24:25], v[24:25], v[72:73]
    v_pk_add_f32 v[26:27], v[26:27], v[74:75]
    v_pk_add_f32 v[28:29], v[28:29], v[76:77]
    v_pk_add_f32 v[30:31], v[30:31], v[78:79]
    v_pk_add_f32 v[32:33], v[32:33], v[80:81]
    v_pk_add_f32 v[34:35], v[34:35], v[82:83]
    s_waitcnt lgkmcnt(3)
    v_pk_add_f32 v[24:25], v[24:25], v[84:85]
    v_pk_add_f32 v[26:27], v[26:27], v[86:87]
    v_pk_add_f32 v[28:29], v[28:29], v[88:89]
    v_pk_add_f32 v[30:31], v[30:31], v[90:91]
    v_pk_add_f32 v[32:33], v[32:33], v[92:93]
    v_pk_add_f32 v[34:35], v[34:35], v[94:95]
    s_waitcnt lgkmcnt(0)
    v_pk_add_f32 v[24:25], v[24:25], v[96:97]
    v_pk_add_f32 v[26:27], v[26:27], v[98:99]
    v_pk_add_f32 v[28:29], v[28:29], v[100:101]
    v_pk_add_f32 v[30:31], v[30:31], v[102:103]
    v_pk_add_f32 v[32:33], v[32:33], v[104:105]
    v_pk_add_f32 v[34:35], v[34:35], v[106:107]
    v_cvt_pk_bf16_f32 v16, v24, v25
    v_cvt_pk_bf16_f32 v17, v26, v27
    v_cvt_pk_bf16_f32 v18, v28, v29
    v_cvt_pk_bf16_f32 v19, v30, v31
    v_cvt_pk_bf16_f32 v20, v32, v33
    v_cvt_pk_bf16_f32 v21, v34, v35
    s_add_u32 s42, s38, 11034624
    buffer_store_dwordx4 v[16:19], v1, s[20:23], s42 offen sc1
    v_mov_b32 v12, v20
    v_mov_b32 v13, v21
    s_add_u32 s42, s39, 11034624
    v_mov_b32 v14, v12
    v_mov_b32 v15, v13
    s_nop 1
    v_permlane16_swap_b32 v12, v14
    v_permlane16_swap_b32 v13, v15
    s_mov_b64 exec, s[72:73]
    buffer_store_dwordx4 v[12:15], v23, s[20:23], s42 offen sc1
    s_mov_b64 exec, -1
    v_lshlrev_b32 v24, 16, v16
pad63:
    s_cbranch_execz wretB
    v_and_b32 v25, 0xffff0000, v16
    v_lshlrev_b32 v26, 16, v17
    v_and_b32 v27, 0xffff0000, v17
    v_lshlrev_b32 v28, 16, v18
    v_and_b32 v29, 0xffff0000, v18
    v_lshlrev_b32 v30, 16, v19
    v_and_b32 v31, 0xffff0000, v19
    v_lshlrev_b32 v32, 16, v20
    v_and_b32 v33, 0xffff0000, v20
    v_lshlrev_b32 v34, 16, v21
    v_and_b32 v35, 0xffff0000, v21
    v_pk_add_f32 v[60:61], v[24:25], v[26:27]
    v_pk_mul_f32 v[62:63], v[24:25], v[24:25]
    v_pk_add_f32 v[60:61], v[60:61], v[28:29]
    v_pk_add_f32 v[60:61], v[60:61], v[30:31]
    v_pk_add_f32 v[60:61], v[60:61], v[32:33]
    v_pk_add_f32 v[60:61], v[60:61], v[34:35]
    v_pk_fma_f32 v[62:63], v[26:27], v[26:27], v[62:63]
    v_pk_fma_f32 v[62:63], v[28:29], v[28:29], v[62:63]
    v_pk_fma_f32 v[62:63], v[30:31], v[30:31], v[62:63]
    v_pk_fma_f32 v[62:63], v[32:33], v[32:33], v[62:63]
    v_pk_fma_f32 v[62:63], v[34:35], v[34:35], v[62:63]
    v_add_f32 v60, v60, v61
    v_add_f32 v61, v62, v63
    v_mov_b32 v64, v60
    s_nop 1
    v_permlane16_swap_b32 v60, v64
    s_nop 1
    v_add_f32 v60, v60, v64
    v_mov_b32 v64, v60
    s_nop 1
    v_permlane32_swap_b32 v60, v64
    s_nop 1
    v_add_f32 v60, v60, v64
    v_mov_b32 v64, v61
    s_nop 1
    v_permlane16_swap_b32 v61, v64
    s_nop 1
    v_add_f32 v61, v61, v64
    v_mov_b32 v64, v61
    s_nop 1
    v_permlane32_swap_b32 v61, v64
    s_nop 1
    v_add_f32 v61, v61, v64
    v_lshlrev_b32 v6, 6, v0
    s_lshl_b32 s42, s19, 10
    s_lshl_b32 s43, s13, 3
    s_add_u32 s42, s42, s43
    s_add_u32 s42, s42, 12214272
    s_mov_b64 exec, 0xffff
    buffer_store_dwordx2 v[60:61], v6, s[20:23], s42 offen sc1
    s_mov_b64 exec, -1
p5_fin:
    s_cmp_lg_u32 s3, 3
    s_cbranch_scc1 on4761
    s_add_u32 s42, s79, 2662400
    buffer_load_dwordx4 a[96:99], v1, s[20:23], s42 offen offset:0
    buffer_load_dwordx4 a[100:103], v1, s[20:23], s42 offen offset:1024
    buffer_load_dwordx4 a[104:107], v1, s[20:23], s42 offen offset:2048
    buffer_load_dwordx4 a[108:111], v1, s[20:23], s42 offen offset:3072
    s_add_u32 s42, s79, 2666496
    buffer_load_dwordx4 a[112:115], v1, s[20:23], s42 offen offset:0
    buffer_load_dwordx4 a[116:119], v1, s[20:23], s42 offen offset:1024
    buffer_load_dwordx4 a[120:123], v1, s[20:23], s42 offen offset:2048
    buffer_load_dwordx4 a[124:127], v1, s[20:23], s42 offen offset:3072
    s_add_u32 s42, s79, 2670592
    buffer_load_dwordx4 a[128:131], v1, s[20:23], s42 offen offset:0
    buffer_load_dwordx4 a[132:135], v1, s[20:23], s42 offen offset:1024
    buffer_load_dwordx4 a[136:139], v1, s[20:23], s42 offen offset:2048
    buffer_load_dwordx4 a[140:143], v1, s[20:23], s42 offen offset:3072
on4761:
    s_barrier
    s_cmp_lg_u32 s3, 0
    s_cbranch_scc1 kb_s0_4780
    s_add_u32 s42, s46, 8192
    s_mov_b64 exec, 1
    v_mov_b32 v6, 1
    v_lshlrev_b32 v7, 8, v0
    buffer_store_dword v6, v7, s[20:23], s42 offen sc1
    s_mov_b64 exec, -1
kb_s0_4780:
pad64:
    s_cbranch_execz wretB
    s_cmp_eq_u32 s3, 3
    s_cbranch_scc1 on4789
    s_add_u32 s42, s79, 2662400
    buffer_load_dwordx4 a[96:99], v1, s[20:23], s42 offen offset:0
    buffer_load_dwordx4 a[100:103], v1, s[20:23], s42 offen offset:1024
    buffer_load_dwordx4 a[104:107], v1, s[20:23], s42 offen offset:2048
    buffer_load_dwordx4 a[108:111], v1, s[20:23], s42 offen offset:3072
    s_add_u32 s42, s79, 2666496
    buffer_load_dwordx4 a[112:115], v1, s[20:23], s42 offen offset:0
    buffer_load_dwordx4 a[116:119], v1, s[20:23], s42 offen offset:1024
    buffer_load_dwordx4 a[120:123], v1, s[20:23], s42 offen offset:2048
    buffer_load_dwordx4 a[124:127], v1, s[20:23], s42 offen offset:3072
    s_add_u32 s42, s79, 2670592
    buffer_load_dwordx4 a[128:131], v1, s[20:23], s42 offen offset:0
    buffer_load_dwordx4 a[132:135], v1, s[20:23], s42 offen offset:1024
    buffer_load_dwordx4 a[136:139], v1, s[20:23], s42 offen offset:2048
    buffer_load_dwordx4 a[140:143], v1, s[20:23], s42 offen offset:3072
on4789:
    s_cmp_lg_u32 s3, 3
    s_cbranch_scc1 kb_w4807_d
    s_add_u32 s42, s45, 8192
    v_lshrrev_b32 v7, 3, v0
    v_lshlrev_b32 v7, 7, v7
    v_and_b32 v6, 7, v0
    v_lshl_add_u32 v7, v6, 2, v7
    s_mov_b32 s43, 0x40000
    s_mov_b32 exec_lo, 0xff
    s_mov_b32 exec_hi, 0x0
kb_w4807:
    buffer_load_dword v6, v5, s[20:23], s42 offen sc1
    s_sub_u32 s43, s43, 1
    s_cbranch_scc1 kb_w4807_x
    s_waitcnt vmcnt(0)
    v_cmp_ne_u32 vcc, 1, v6
    s_cbranch_vccnz kb_w4807
kb_w4807_x:
    s_mov_b64 exec, -1
kb_w4807_d:
    s_barrier
p6_re:
    s_min_u32 s43, s3, 2
    s_add_u32 s42, s14, s43
    s_lshl_b32 s42, s42, 10
    s_add_u32 s42, s42, 12214272
    v_lshlrev_b32 v6, 6, v3
    v_lshl_add_u32 v6, v2, 4, v6
    buffer_load_dwordx4 v[12:15], v6, s[20:23], s42 offen sc1
    s_add_u32 s32, s16, 11034624
    s_add_u32 s33, s16, 11046912
    s_add_u32 s34, s16, 11059200
    buffer_load_dwordx4 v[60:63], v1, s[20:23], s32 offen offset:0 sc1
    buffer_load_dwordx4 v[64:67], v1, s[20:23], s33 offen offset:0 sc1
    buffer_load_dwordx4 v[68:71], v1, s[20:23], s34 offen offset:0 sc1
    buffer_load_dwordx4 v[72:75], v1, s[20:23], s32 offen offset:1024 sc1
    buffer_load_dwordx4 v[76:79], v1, s[20:23], s33 offen offset:1024 sc1
    buffer_load_dwordx4 v[80:83], v1, s[20:23], s34 offen offset:1024 sc1
    buffer_load_dwordx4 v[84:87], v1, s[20:23], s32 offen offset:2048 sc1
    buffer_load_dwordx4 v[88:91], v1, s[20:23], s33 offen offset:2048 sc1
    buffer_load_dwordx4 v[92:95], v1, s[20:23], s34 offen offset:2048 sc1
    s_mul_i32 s42, s3, 9216
    v_add_u32 v6, s42, v1
    s_lshl_b32 s43, s43, 7
    s_add_u32 s43, s43, 75776
    v_lshl_add_u32 v7, v3, 3, s43
    s_waitcnt vmcnt(9)
    v_max_u32 v8, v12, v14
    v_pk_add_f32 v[12:13], v[12:13], v[14:15]
    v_mov_b32 v14, v12
    s_nop 1
    v_permlane16_swap_b32 v12, v14
    s_nop 1
    v_add_f32 v12, v12, v14
    v_mov_b32 v14, v12
    s_nop 1
    v_permlane32_swap_b32 v12, v14
    s_nop 1
    v_add_f32 v12, v12, v14
    v_mov_b32 v14, v13
    s_nop 1
    v_permlane16_swap_b32 v13, v14
    s_nop 1
pad65:
    s_cbranch_execz wretB
    v_add_f32 v13, v13, v14
    v_mov_b32 v14, v13
    s_nop 1
    v_permlane32_swap_b32 v13, v14
    s_nop 1
    v_add_f32 v13, v13, v14
    v_mul_f32 v12, 0x3b2aaaab, v12
    v_mul_f32 v13, 0x3b2aaaab, v13
    v_fma_f32 v13, -v12, v12, v13
    v_max_f32 v13, 0, v13
    v_add_f32 v13, 0x3727c5ac, v13
    v_rsq_f32 v13, v13
    s_nop 0
    ds_write_b64 v7, v[12:13]
    s_waitcnt vmcnt(8)
    ds_write_b128 v6, v[60:63] offset:0
    v_max_u32 v8, v8, v60
    s_waitcnt vmcnt(7)
    ds_write_b128 v6, v[64:67] offset:1024
    v_max_u32 v8, v8, v64
    s_waitcnt vmcnt(6)
    ds_write_b128 v6, v[68:71] offset:2048
    v_max_u32 v8, v8, v68
    s_waitcnt vmcnt(5)
    ds_write_b128 v6, v[72:75] offset:3072
    v_max_u32 v8, v8, v72
    s_waitcnt vmcnt(4)
    ds_write_b128 v6, v[76:79] offset:4096
    v_max_u32 v8, v8, v76
    s_waitcnt vmcnt(3)
    ds_write_b128 v6, v[80:83] offset:5120
    v_max_u32 v8, v8, v80
    s_waitcnt vmcnt(2)
    ds_write_b128 v6, v[84:87] offset:6144
    v_max_u32 v8, v8, v84
    s_waitcnt vmcnt(1)
    ds_write_b128 v6, v[88:91] offset:7168
    v_max_u32 v8, v8, v88
    s_waitcnt vmcnt(0)
    ds_write_b128 v6, v[92:95] offset:8192
    v_max_u32 v8, v8, v92
    s_waitcnt lgkmcnt(0)
    v_cmp_eq_u32 vcc, -1, v8
    s_cbranch_vccz p6_re_ok
    s_sub_u32 s40, s40, 1
    s_cbranch_scc0 p6_re
    s_mov_b32 s40, 0
p6_re_ok:
    s_barrier
    s_mul_i32 s43, s3, 384
    s_add_u32 s43, s43, 76160
    v_lshlrev_b32 v7, 3, v3
    v_add_u32 v7, 75776, v7
    s_lshl_b32 s42, s65, 7
    s_add_u32 s42, s42, s43
    v_lshl_add_u32 v6, v2, 5, s42
    ds_read_b128 v[100:103], v6
    ds_read_b128 v[104:107], v6 offset:16
    ds_read_b64 v[124:125], v7 offset:0
    s_lshl_b32 s42, s66, 7
    s_add_u32 s42, s42, s43
    v_lshl_add_u32 v6, v2, 5, s42
    ds_read_b128 v[108:111], v6
    ds_read_b128 v[112:115], v6 offset:16
    ds_read_b64 v[126:127], v7 offset:128
    s_lshl_b32 s42, s67, 7
    s_add_u32 s42, s42, s43
    v_lshl_add_u32 v6, v2, 5, s42
    ds_read_b128 v[116:119], v6
    ds_read_b128 v[120:123], v6 offset:16
    ds_read_b64 v[128:129], v7 offset:256
    ds_read_b128 v[60:63], v1 offset:0
    ds_read_b128 v[64:67], v1 offset:1024
    ds_read_b128 v[68:71], v1 offset:2048
    ds_read_b128 v[72:75], v1 offset:3072
    ds_read_b128 v[76:79], v1 offset:4096
    ds_read_b128 v[80:83], v1 offset:5120
    ds_read_b128 v[84:87], v1 offset:6144
    ds_read_b128 v[88:91], v1 offset:7168
    ds_read_b128 v[92:95], v1 offset:8192
    s_waitcnt lgkmcnt(6)
pad66:
    s_cbranch_execz wretB
    v_mfma_f32_16x16x32_bf16 v[24:27], a[144:147], v[60:63], 0
    v_mfma_f32_16x16x32_bf16 v[28:31], a[192:195], v[60:63], 0
    v_mfma_f32_16x16x32_bf16 v[32:35], a[240:243], v[60:63], 0
    s_add_u32 s42, s77, 2662400
    buffer_load_dwordx4 a[0:3], v1, s[20:23], s42 offen
    v_mfma_f32_16x16x32_bf16 v[36:39], a[144:147], v[64:67], 0
    v_mfma_f32_16x16x32_bf16 v[40:43], a[192:195], v[64:67], 0
    v_mfma_f32_16x16x32_bf16 v[44:47], a[240:243], v[64:67], 0
    s_add_u32 s42, s78, 2662400
    buffer_load_dwordx4 a[48:51], v1, s[20:23], s42 offen
    v_mfma_f32_16x16x32_bf16 v[48:51], a[144:147], v[68:71], 0
    v_mfma_f32_16x16x32_bf16 v[52:55], a[192:195], v[68:71], 0
    v_mfma_f32_16x16x32_bf16 v[56:59], a[240:243], v[68:71], 0
    ds_read_b128 v[60:63], v1 offset:9216
    ds_read_b128 v[64:67], v1 offset:10240
    ds_read_b128 v[68:71], v1 offset:11264
    s_waitcnt lgkmcnt(6)
    v_mfma_f32_16x16x32_bf16 v[24:27], a[148:151], v[72:75], v[24:27]
    v_mfma_f32_16x16x32_bf16 v[28:31], a[196:199], v[72:75], v[28:31]
    v_mfma_f32_16x16x32_bf16 v[32:35], a[244:247], v[72:75], v[32:35]
    s_add_u32 s42, s77, 2663424
    buffer_load_dwordx4 a[4:7], v1, s[20:23], s42 offen
    v_mfma_f32_16x16x32_bf16 v[36:39], a[148:151], v[76:79], v[36:39]
    v_mfma_f32_16x16x32_bf16 v[40:43], a[196:199], v[76:79], v[40:43]
    v_mfma_f32_16x16x32_bf16 v[44:47], a[244:247], v[76:79], v[44:47]
    s_add_u32 s42, s78, 2663424
    buffer_load_dwordx4 a[52:55], v1, s[20:23], s42 offen
    v_mfma_f32_16x16x32_bf16 v[48:51], a[148:151], v[80:83], v[48:51]
    v_mfma_f32_16x16x32_bf16 v[52:55], a[196:199], v[80:83], v[52:55]
    v_mfma_f32_16x16x32_bf16 v[56:59], a[244:247], v[80:83], v[56:59]
    ds_read_b128 v[72:75], v1 offset:12288
    ds_read_b128 v[76:79], v1 offset:13312
    ds_read_b128 v[80:83], v1 offset:14336
    s_waitcnt lgkmcnt(6)
    v_mfma_f32_16x16x32_bf16 v[24:27], a[152:155], v[84:87], v[24:27]
    v_mfma_f32_16x16x32_bf16 v[28:31], a[200:203], v[84:87], v[28:31]
    v_mfma_f32_16x16x32_bf16 v[32:35], a[248:251], v[84:87], v[32:35]
    s_add_u32 s42, s77, 2664448
    buffer_load_dwordx4 a[8:11], v1, s[20:23], s42 offen
    v_mfma_f32_16x16x32_bf16 v[36:39], a[152:155], v[88:91], v[36:39]
    v_mfma_f32_16x16x32_bf16 v[40:43], a[200:203], v[88:91], v[40:43]
    v_mfma_f32_16x16x32_bf16 v[44:47], a[248:251], v[88:91], v[44:47]
    s_add_u32 s42, s78, 2664448
    buffer_load_dwordx4 a[56:59], v1, s[20:23], s42 offen
    v_mfma_f32_16x16x32_bf16 v[48:51], a[152:155], v[92:95], v[48:51]
    v_mfma_f32_16x16x32_bf16 v[52:55], a[200:203], v[92:95], v[52:55]
    v_mfma_f32_16x16x32_bf16 v[56:59], a[248:251], v[92:95], v[56:59]
    ds_read_b128 v[84:87], v1 offset:15360
    ds_read_b128 v[88:91], v1 offset:16384
    ds_read_b128 v[92:95], v1 offset:17408
    s_waitcnt lgkmcnt(6)
    v_mfma_f32_16x16x32_bf16 v[24:27], a[156:159], v[60:63], v[24:27]
    v_mfma_f32_16x16x32_bf16 v[28:31], a[204:207], v[60:63], v[28:31]
    v_mfma_f32_16x16x32_bf16 v[32:35], a[252:255], v[60:63], v[32:35]
    s_add_u32 s42, s77, 2665472
    buffer_load_dwordx4 a[12:15], v1, s[20:23], s42 offen
    v_mfma_f32_16x16x32_bf16 v[36:39], a[156:159], v[64:67], v[36:39]
    v_mfma_f32_16x16x32_bf16 v[40:43], a[204:207], v[64:67], v[40:43]
    v_mfma_f32_16x16x32_bf16 v[44:47], a[252:255], v[64:67], v[44:47]
    s_add_u32 s42, s78, 2665472
    buffer_load_dwordx4 a[60:63], v1, s[20:23], s42 offen
    v_mfma_f32_16x16x32_bf16 v[48:51], a[156:159], v[68:71], v[48:51]
    v_mfma_f32_16x16x32_bf16 v[52:55], a[204:207], v[68:71], v[52:55]
    v_mfma_f32_16x16x32_bf16 v[56:59], a[252:255], v[68:71], v[56:59]
    ds_read_b128 v[60:63], v1 offset:18432
pad67:
    s_cbranch_execz wretB
    ds_read_b128 v[64:67], v1 offset:19456
    ds_read_b128 v[68:71], v1 offset:20480
    s_waitcnt lgkmcnt(6)
    v_mfma_f32_16x16x32_bf16 v[24:27], a[160:163], v[72:75], v[24:27]
    v_mfma_f32_16x16x32_bf16 v[28:31], a[208:211], v[72:75], v[28:31]
    v_mfma_f32_16x16x32_bf16 v[32:35], v[224:227], v[72:75], v[32:35]
    s_add_u32 s42, s77, 2666496
    buffer_load_dwordx4 a[16:19], v1, s[20:23], s42 offen
    v_mfma_f32_16x16x32_bf16 v[36:39], a[160:163], v[76:79], v[36:39]
    v_mfma_f32_16x16x32_bf16 v[40:43], a[208:211], v[76:79], v[40:43]
    v_mfma_f32_16x16x32_bf16 v[44:47], v[224:227], v[76:79], v[44:47]
    s_add_u32 s42, s78, 2666496
    buffer_load_dwordx4 a[64:67], v1, s[20:23], s42 offen
    v_mfma_f32_16x16x32_bf16 v[48:51], a[160:163], v[80:83], v[48:51]
    v_mfma_f32_16x16x32_bf16 v[52:55], a[208:211], v[80:83], v[52:55]
    v_mfma_f32_16x16x32_bf16 v[56:59], v[224:227], v[80:83], v[56:59]
    ds_read_b128 v[72:75], v1 offset:21504
    ds_read_b128 v[76:79], v1 offset:22528
    ds_read_b128 v[80:83], v1 offset:23552
    s_waitcnt lgkmcnt(6)
    v_mfma_f32_16x16x32_bf16 v[24:27], a[164:167], v[84:87], v[24:27]
    v_mfma_f32_16x16x32_bf16 v[28:31], a[212:215], v[84:87], v[28:31]
    v_mfma_f32_16x16x32_bf16 v[32:35], v[228:231], v[84:87], v[32:35]
    s_add_u32 s42, s77, 2667520
    buffer_load_dwordx4 a[20:23], v1, s[20:23], s42 offen
    v_mfma_f32_16x16x32_bf16 v[36:39], a[164:167], v[88:91], v[36:39]
    v_mfma_f32_16x16x32_bf16 v[40:43], a[212:215], v[88:91], v[40:43]
    v_mfma_f32_16x16x32_bf16 v[44:47], v[228:231], v[88:91], v[44:47]
    s_add_u32 s42, s78, 2667520
    buffer_load_dwordx4 a[68:71], v1, s[20:23], s42 offen
    v_mfma_f32_16x16x32_bf16 v[48:51], a[164:167], v[92:95], v[48:51]
    v_mfma_f32_16x16x32_bf16 v[52:55], a[212:215], v[92:95], v[52:55]
    v_mfma_f32_16x16x32_bf16 v[56:59], v[228:231], v[92:95], v[56:59]
    ds_read_b128 v[84:87], v1 offset:24576
    ds_read_b128 v[88:91], v1 offset:25600
    ds_read_b128 v[92:95], v1 offset:26624
    s_waitcnt lgkmcnt(6)
    v_mfma_f32_16x16x32_bf16 v[24:27], a[168:171], v[60:63], v[24:27]
    v_mfma_f32_16x16x32_bf16 v[28:31], a[216:219], v[60:63], v[28:31]
    v_mfma_f32_16x16x32_bf16 v[32:35], v[232:235], v[60:63], v[32:35]
    s_add_u32 s42, s77, 2668544
    buffer_load_dwordx4 a[24:27], v1, s[20:23], s42 offen
    v_mfma_f32_16x16x32_bf16 v[36:39], a[168:171], v[64:67], v[36:39]
    v_mfma_f32_16x16x32_bf16 v[40:43], a[216:219], v[64:67], v[40:43]
    v_mfma_f32_16x16x32_bf16 v[44:47], v[232:235], v[64:67], v[44:47]
    s_add_u32 s42, s78, 2668544
    buffer_load_dwordx4 a[72:75], v1, s[20:23], s42 offen
    v_mfma_f32_16x16x32_bf16 v[48:51], a[168:171], v[68:71], v[48:51]
    v_mfma_f32_16x16x32_bf16 v[52:55], a[216:219], v[68:71], v[52:55]
    v_mfma_f32_16x16x32_bf16 v[56:59], v[232:235], v[68:71], v[56:59]
    ds_read_b128 v[60:63], v1 offset:27648
    ds_read_b128 v[64:67], v1 offset:28672
    ds_read_b128 v[68:71], v1 offset:29696
    s_waitcnt lgkmcnt(6)
    v_mfma_f32_16x16x32_bf16 v[24:27], a[172:175], v[72:75], v[24:27]
    v_mfma_f32_16x16x32_bf16 v[28:31], a[220:223], v[72:75], v[28:31]
    v_mfma_f32_16x16x32_bf16 v[32:35], v[236:239], v[72:75], v[32:35]
    s_add_u32 s42, s77, 2669568
    buffer_load_dwordx4 a[28:31], v1, s[20:23], s42 offen
    v_mfma_f32_16x16x32_bf16 v[36:39], a[172:175], v[76:79], v[36:39]
    v_mfma_f32_16x16x32_bf16 v[40:43], a[220:223], v[76:79], v[40:43]
    v_mfma_f32_16x16x32_bf16 v[44:47], v[236:239], v[76:79], v[44:47]
    s_add_u32 s42, s78, 2669568
    buffer_load_dwordx4 a[76:79], v1, s[20:23], s42 offen
    v_mfma_f32_16x16x32_bf16 v[48:51], a[172:175], v[80:83], v[48:51]
    v_mfma_f32_16x16x32_bf16 v[52:55], a[220:223], v[80:83], v[52:55]
pad68:
    s_cbranch_execz wretB
    v_mfma_f32_16x16x32_bf16 v[56:59], v[236:239], v[80:83], v[56:59]
    ds_read_b128 v[72:75], v1 offset:30720
    ds_read_b128 v[76:79], v1 offset:31744
    ds_read_b128 v[80:83], v1 offset:32768
    s_waitcnt lgkmcnt(6)
    v_mfma_f32_16x16x32_bf16 v[24:27], a[176:179], v[84:87], v[24:27]
    v_mfma_f32_16x16x32_bf16 v[28:31], a[224:227], v[84:87], v[28:31]
    v_mfma_f32_16x16x32_bf16 v[32:35], v[240:243], v[84:87], v[32:35]
    s_add_u32 s42, s77, 2670592
    buffer_load_dwordx4 a[32:35], v1, s[20:23], s42 offen
    v_mfma_f32_16x16x32_bf16 v[36:39], a[176:179], v[88:91], v[36:39]
    v_mfma_f32_16x16x32_bf16 v[40:43], a[224:227], v[88:91], v[40:43]
    v_mfma_f32_16x16x32_bf16 v[44:47], v[240:243], v[88:91], v[44:47]
    s_add_u32 s42, s78, 2670592
    buffer_load_dwordx4 a[80:83], v1, s[20:23], s42 offen
    v_mfma_f32_16x16x32_bf16 v[48:51], a[176:179], v[92:95], v[48:51]
    v_mfma_f32_16x16x32_bf16 v[52:55], a[224:227], v[92:95], v[52:55]
    v_mfma_f32_16x16x32_bf16 v[56:59], v[240:243], v[92:95], v[56:59]
    ds_read_b128 v[84:87], v1 offset:33792
    ds_read_b128 v[88:91], v1 offset:34816
    ds_read_b128 v[92:95], v1 offset:35840
    s_waitcnt lgkmcnt(6)
    v_mfma_f32_16x16x32_bf16 v[24:27], a[180:183], v[60:63], v[24:27]
    v_mfma_f32_16x16x32_bf16 v[28:31], a[228:231], v[60:63], v[28:31]
    v_mfma_f32_16x16x32_bf16 v[32:35], v[244:247], v[60:63], v[32:35]
    s_add_u32 s42, s77, 2671616
    buffer_load_dwordx4 a[36:39], v1, s[20:23], s42 offen
    v_mfma_f32_16x16x32_bf16 v[36:39], a[180:183], v[64:67], v[36:39]
    v_mfma_f32_16x16x32_bf16 v[40:43], a[228:231], v[64:67], v[40:43]
    v_mfma_f32_16x16x32_bf16 v[44:47], v[244:247], v[64:67], v[44:47]
    s_add_u32 s42, s78, 2671616
    buffer_load_dwordx4 a[84:87], v1, s[20:23], s42 offen
    v_mfma_f32_16x16x32_bf16 v[48:51], a[180:183], v[68:71], v[48:51]
    v_mfma_f32_16x16x32_bf16 v[52:55], a[228:231], v[68:71], v[52:55]
    v_mfma_f32_16x16x32_bf16 v[56:59], v[244:247], v[68:71], v[56:59]
    s_waitcnt lgkmcnt(3)
    v_mfma_f32_16x16x32_bf16 v[24:27], a[184:187], v[72:75], v[24:27]
    v_mfma_f32_16x16x32_bf16 v[28:31], a[232:235], v[72:75], v[28:31]
    v_mfma_f32_16x16x32_bf16 v[32:35], v[248:251], v[72:75], v[32:35]
    s_add_u32 s42, s77, 2672640
    buffer_load_dwordx4 a[40:43], v1, s[20:23], s42 offen
    v_mfma_f32_16x16x32_bf16 v[36:39], a[184:187], v[76:79], v[36:39]
    v_mfma_f32_16x16x32_bf16 v[40:43], a[232:235], v[76:79], v[40:43]
    v_mfma_f32_16x16x32_bf16 v[44:47], v[248:251], v[76:79], v[44:47]
    s_add_u32 s42, s78, 2672640
    buffer_load_dwordx4 a[88:91], v1, s[20:23], s42 offen
    v_mfma_f32_16x16x32_bf16 v[48:51], a[184:187], v[80:83], v[48:51]
    v_mfma_f32_16x16x32_bf16 v[52:55], a[232:235], v[80:83], v[52:55]
    v_mfma_f32_16x16x32_bf16 v[56:59], v[248:251], v[80:83], v[56:59]
    s_waitcnt lgkmcnt(0)
    v_mfma_f32_16x16x32_bf16 v[24:27], a[188:191], v[84:87], v[24:27]
    v_mfma_f32_16x16x32_bf16 v[28:31], a[236:239], v[84:87], v[28:31]
    v_mfma_f32_16x16x32_bf16 v[32:35], v[252:255], v[84:87], v[32:35]
    s_add_u32 s42, s77, 2673664
    buffer_load_dwordx4 a[44:47], v1, s[20:23], s42 offen
    v_mfma_f32_16x16x32_bf16 v[36:39], a[188:191], v[88:91], v[36:39]
    v_mfma_f32_16x16x32_bf16 v[40:43], a[236:239], v[88:91], v[40:43]
    v_mfma_f32_16x16x32_bf16 v[44:47], v[252:255], v[88:91], v[44:47]
    s_add_u32 s42, s78, 2673664
    buffer_load_dwordx4 a[92:95], v1, s[20:23], s42 offen
    v_mfma_f32_16x16x32_bf16 v[48:51], a[188:191], v[92:95], v[48:51]
    v_mfma_f32_16x16x32_bf16 v[52:55], a[236:239], v[92:95], v[52:55]
    v_mfma_f32_16x16x32_bf16 v[56:59], v[252:255], v[92:95], v[56:59]
    s_mov_b32 s60, 0xbdd2d3e8
    s_mov_b32 s61, s60
    v_mov_b32 v10, 0xc0135761
pad69:
    s_cbranch_execz wretB
    v_mov_b32 v11, v10
    s_mul_i32 s47, s14, 49152
    s_mul_i32 s48, s13, 6144
    s_add_u32 s47, s47, s48
    s_lshr_b32 s48, s3, 1
    s_mul_i32 s48, s48, 3072
    s_add_u32 s47, s47, s48
    s_add_u32 s47, s47, 12312576
    s_add_u32 s50, s47, s70
    s_add_u32 s51, s47, s71
    s_add_u32 s52, s51, 98304
    v_and_b32 v6, 1, v2
    v_mul_u32_u24 v6, 49152, v6
    v_add_u32 v6, v6, v23
    v_fma_f32 v24, -v100, v124, v24
    v_mul_f32 v24, v24, v125
    v_fma_f32 v25, -v102, v124, v25
    v_mul_f32 v25, v25, v125
    v_fma_f32 v26, -v104, v124, v26
    v_mul_f32 v26, v26, v125
    v_fma_f32 v27, -v106, v124, v27
    v_mul_f32 v27, v27, v125
    v_fma_f32 v28, -v108, v124, v28
    v_mul_f32 v28, v28, v125
    v_fma_f32 v29, -v110, v124, v29
    v_mul_f32 v29, v29, v125
    v_fma_f32 v30, -v112, v124, v30
    v_mul_f32 v30, v30, v125
    v_fma_f32 v31, -v114, v124, v31
    v_mul_f32 v31, v31, v125
    v_fma_f32 v32, -v116, v124, v32
    v_mul_f32 v32, v32, v125
    v_fma_f32 v33, -v118, v124, v33
    v_mul_f32 v33, v33, v125
    v_fma_f32 v34, -v120, v124, v34
    v_mul_f32 v34, v34, v125
    v_fma_f32 v35, -v122, v124, v35
    v_mul_f32 v35, v35, v125
    v_pk_mul_f32 v[132:133], v[24:25], v[24:25]
    v_pk_fma_f32 v[132:133], v[132:133], s[60:61], v[10:11]
    v_pk_mul_f32 v[132:133], v[132:133], v[24:25]
    v_pk_mul_f32 v[134:135], v[26:27], v[26:27]
    v_pk_fma_f32 v[134:135], v[134:135], s[60:61], v[10:11]
    v_pk_mul_f32 v[134:135], v[134:135], v[26:27]
    v_pk_mul_f32 v[136:137], v[28:29], v[28:29]
    v_pk_fma_f32 v[136:137], v[136:137], s[60:61], v[10:11]
    v_pk_mul_f32 v[136:137], v[136:137], v[28:29]
    v_pk_mul_f32 v[138:139], v[30:31], v[30:31]
    v_pk_fma_f32 v[138:139], v[138:139], s[60:61], v[10:11]
    v_pk_mul_f32 v[138:139], v[138:139], v[30:31]
    v_pk_mul_f32 v[140:141], v[32:33], v[32:33]
    v_pk_fma_f32 v[140:141], v[140:141], s[60:61], v[10:11]
    v_pk_mul_f32 v[140:141], v[140:141], v[32:33]
    v_pk_mul_f32 v[142:143], v[34:35], v[34:35]
    v_pk_fma_f32 v[142:143], v[142:143], s[60:61], v[10:11]
    v_pk_mul_f32 v[142:143], v[142:143], v[34:35]
    v_exp_f32 v132, v132
    v_exp_f32 v133, v133
    v_exp_f32 v134, v134
    v_exp_f32 v135, v135
    v_exp_f32 v136, v136
    v_exp_f32 v137, v137
    v_exp_f32 v138, v138
    v_exp_f32 v139, v139
    v_exp_f32 v140, v140
    v_exp_f32 v141, v141
    v_exp_f32 v142, v142
    v_exp_f32 v143, v143
    v_add_f32 v132, 1.0, v132
    v_add_f32 v133, 1.0, v133
    v_add_f32 v134, 1.0, v134
    v_add_f32 v135, 1.0, v135
    v_add_f32 v136, 1.0, v136
    v_add_f32 v137, 1.0, v137
    v_add_f32 v138, 1.0, v138
    v_add_f32 v139, 1.0, v139
    v_add_f32 v140, 1.0, v140
    v_add_f32 v141, 1.0, v141
    v_add_f32 v142, 1.0, v142
    v_add_f32 v143, 1.0, v143
    v_rcp_f32 v132, v132
    v_rcp_f32 v133, v133
    v_rcp_f32 v134, v134
    v_rcp_f32 v135, v135
    v_rcp_f32 v136, v136
    v_rcp_f32 v137, v137
pad70:
    s_cbranch_execz wretB
    v_rcp_f32 v138, v138
    v_rcp_f32 v139, v139
    v_rcp_f32 v140, v140
    v_rcp_f32 v141, v141
    v_rcp_f32 v142, v142
    v_rcp_f32 v143, v143
    v_pk_mul_f32 v[24:25], v[24:25], v[132:133]
    v_pk_mul_f32 v[26:27], v[26:27], v[134:135]
    v_pk_mul_f32 v[28:29], v[28:29], v[136:137]
    v_pk_mul_f32 v[30:31], v[30:31], v[138:139]
    v_pk_mul_f32 v[32:33], v[32:33], v[140:141]
    v_pk_mul_f32 v[34:35], v[34:35], v[142:143]
    v_cvt_pk_bf16_f32 v60, v24, v25
    v_cvt_pk_bf16_f32 v61, v26, v27
    v_cvt_pk_bf16_f32 v62, v28, v29
    v_cvt_pk_bf16_f32 v63, v30, v31
    buffer_store_dwordx4 v[60:63], v1, s[20:23], s50 offen sc1
    s_add_u32 s50, s50, 49152
    v_cvt_pk_bf16_f32 v72, v32, v33
    v_cvt_pk_bf16_f32 v73, v34, v35
    v_fma_f32 v36, -v100, v126, v36
    v_mul_f32 v36, v36, v127
    v_fma_f32 v37, -v102, v126, v37
    v_mul_f32 v37, v37, v127
    v_fma_f32 v38, -v104, v126, v38
    v_mul_f32 v38, v38, v127
    v_fma_f32 v39, -v106, v126, v39
    v_mul_f32 v39, v39, v127
    v_fma_f32 v40, -v108, v126, v40
    v_mul_f32 v40, v40, v127
    v_fma_f32 v41, -v110, v126, v41
    v_mul_f32 v41, v41, v127
    v_fma_f32 v42, -v112, v126, v42
    v_mul_f32 v42, v42, v127
    v_fma_f32 v43, -v114, v126, v43
    v_mul_f32 v43, v43, v127
    v_fma_f32 v44, -v116, v126, v44
    v_mul_f32 v44, v44, v127
    v_fma_f32 v45, -v118, v126, v45
    v_mul_f32 v45, v45, v127
    v_fma_f32 v46, -v120, v126, v46
    v_mul_f32 v46, v46, v127
    v_fma_f32 v47, -v122, v126, v47
    v_mul_f32 v47, v47, v127
    v_pk_mul_f32 v[132:133], v[36:37], v[36:37]
    v_pk_fma_f32 v[132:133], v[132:133], s[60:61], v[10:11]
    v_pk_mul_f32 v[132:133], v[132:133], v[36:37]
    v_pk_mul_f32 v[134:135], v[38:39], v[38:39]
    v_pk_fma_f32 v[134:135], v[134:135], s[60:61], v[10:11]
    v_pk_mul_f32 v[134:135], v[134:135], v[38:39]
    v_pk_mul_f32 v[136:137], v[40:41], v[40:41]
    v_pk_fma_f32 v[136:137], v[136:137], s[60:61], v[10:11]
    v_pk_mul_f32 v[136:137], v[136:137], v[40:41]
    v_pk_mul_f32 v[138:139], v[42:43], v[42:43]
    v_pk_fma_f32 v[138:139], v[138:139], s[60:61], v[10:11]
    v_pk_mul_f32 v[138:139], v[138:139], v[42:43]
    v_pk_mul_f32 v[140:141], v[44:45], v[44:45]
    v_pk_fma_f32 v[140:141], v[140:141], s[60:61], v[10:11]
    v_pk_mul_f32 v[140:141], v[140:141], v[44:45]
    v_pk_mul_f32 v[142:143], v[46:47], v[46:47]
    v_pk_fma_f32 v[142:143], v[142:143], s[60:61], v[10:11]
    v_pk_mul_f32 v[142:143], v[142:143], v[46:47]
    v_exp_f32 v132, v132
    v_exp_f32 v133, v133
    v_exp_f32 v134, v134
    v_exp_f32 v135, v135
    v_exp_f32 v136, v136
    v_exp_f32 v137, v137
    v_exp_f32 v138, v138
    v_exp_f32 v139, v139
    v_exp_f32 v140, v140
    v_exp_f32 v141, v141
    v_exp_f32 v142, v142
    v_exp_f32 v143, v143
    v_add_f32 v132, 1.0, v132
    v_add_f32 v133, 1.0, v133
    v_add_f32 v134, 1.0, v134
    v_add_f32 v135, 1.0, v135
    v_add_f32 v136, 1.0, v136
    v_add_f32 v137, 1.0, v137
    v_add_f32 v138, 1.0, v138
    v_add_f32 v139, 1.0, v139
    v_add_f32 v140, 1.0, v140
pad71:
    s_cbranch_execz wretB
    v_add_f32 v141, 1.0, v141
    v_add_f32 v142, 1.0, v142
    v_add_f32 v143, 1.0, v143
    v_rcp_f32 v132, v132
    v_rcp_f32 v133, v133
    v_rcp_f32 v134, v134
    v_rcp_f32 v135, v135
    v_rcp_f32 v136, v136
    v_rcp_f32 v137, v137
    v_rcp_f32 v138, v138
    v_rcp_f32 v139, v139
    v_rcp_f32 v140, v140
    v_rcp_f32 v141, v141
    v_rcp_f32 v142, v142
    v_rcp_f32 v143, v143
    v_pk_mul_f32 v[36:37], v[36:37], v[132:133]
    v_pk_mul_f32 v[38:39], v[38:39], v[134:135]
    v_pk_mul_f32 v[40:41], v[40:41], v[136:137]
    v_pk_mul_f32 v[42:43], v[42:43], v[138:139]
    v_pk_mul_f32 v[44:45], v[44:45], v[140:141]
    v_pk_mul_f32 v[46:47], v[46:47], v[142:143]
    v_cvt_pk_bf16_f32 v64, v36, v37
    v_cvt_pk_bf16_f32 v65, v38, v39
    v_cvt_pk_bf16_f32 v66, v40, v41
    v_cvt_pk_bf16_f32 v67, v42, v43
    buffer_store_dwordx4 v[64:67], v1, s[20:23], s50 offen sc1
    s_add_u32 s50, s50, 49152
    v_cvt_pk_bf16_f32 v74, v44, v45
    v_cvt_pk_bf16_f32 v75, v46, v47
    s_nop 1
    v_permlane16_swap_b32 v72, v74
    v_permlane16_swap_b32 v73, v75
    buffer_store_dwordx4 v[72:75], v6, s[20:23], s51 offen sc1
    v_fma_f32 v48, -v100, v128, v48
    v_mul_f32 v48, v48, v129
    v_fma_f32 v49, -v102, v128, v49
    v_mul_f32 v49, v49, v129
    v_fma_f32 v50, -v104, v128, v50
    v_mul_f32 v50, v50, v129
    v_fma_f32 v51, -v106, v128, v51
    v_mul_f32 v51, v51, v129
    v_fma_f32 v52, -v108, v128, v52
    v_mul_f32 v52, v52, v129
    v_fma_f32 v53, -v110, v128, v53
    v_mul_f32 v53, v53, v129
    v_fma_f32 v54, -v112, v128, v54
    v_mul_f32 v54, v54, v129
    v_fma_f32 v55, -v114, v128, v55
    v_mul_f32 v55, v55, v129
    v_fma_f32 v56, -v116, v128, v56
    v_mul_f32 v56, v56, v129
    v_fma_f32 v57, -v118, v128, v57
    v_mul_f32 v57, v57, v129
    v_fma_f32 v58, -v120, v128, v58
    v_mul_f32 v58, v58, v129
    v_fma_f32 v59, -v122, v128, v59
    v_mul_f32 v59, v59, v129
    v_pk_mul_f32 v[132:133], v[48:49], v[48:49]
    v_pk_fma_f32 v[132:133], v[132:133], s[60:61], v[10:11]
    v_pk_mul_f32 v[132:133], v[132:133], v[48:49]
    v_pk_mul_f32 v[134:135], v[50:51], v[50:51]
    v_pk_fma_f32 v[134:135], v[134:135], s[60:61], v[10:11]
    v_pk_mul_f32 v[134:135], v[134:135], v[50:51]
    v_pk_mul_f32 v[136:137], v[52:53], v[52:53]
    v_pk_fma_f32 v[136:137], v[136:137], s[60:61], v[10:11]
    v_pk_mul_f32 v[136:137], v[136:137], v[52:53]
    v_pk_mul_f32 v[138:139], v[54:55], v[54:55]
    v_pk_fma_f32 v[138:139], v[138:139], s[60:61], v[10:11]
    v_pk_mul_f32 v[138:139], v[138:139], v[54:55]
    v_pk_mul_f32 v[140:141], v[56:57], v[56:57]
    v_pk_fma_f32 v[140:141], v[140:141], s[60:61], v[10:11]
    v_pk_mul_f32 v[140:141], v[140:141], v[56:57]
    v_pk_mul_f32 v[142:143], v[58:59], v[58:59]
    v_pk_fma_f32 v[142:143], v[142:143], s[60:61], v[10:11]
    v_pk_mul_f32 v[142:143], v[142:143], v[58:59]
    v_exp_f32 v132, v132
    v_exp_f32 v133, v133
    v_exp_f32 v134, v134
    v_exp_f32 v135, v135
    v_exp_f32 v136, v136
pad72:
    s_cbranch_execz wretB
    v_exp_f32 v137, v137
    v_exp_f32 v138, v138
    v_exp_f32 v139, v139
    v_exp_f32 v140, v140
    v_exp_f32 v141, v141
    v_exp_f32 v142, v142
    v_exp_f32 v143, v143
    v_add_f32 v132, 1.0, v132
    v_add_f32 v133, 1.0, v133
    v_add_f32 v134, 1.0, v134
    v_add_f32 v135, 1.0, v135
    v_add_f32 v136, 1.0, v136
    v_add_f32 v137, 1.0, v137
    v_add_f32 v138, 1.0, v138
    v_add_f32 v139, 1.0, v139
    v_add_f32 v140, 1.0, v140
    v_add_f32 v141, 1.0, v141
    v_add_f32 v142, 1.0, v142
    v_add_f32 v143, 1.0, v143
    v_rcp_f32 v132, v132
    v_rcp_f32 v133, v133
    v_rcp_f32 v134, v134
    v_rcp_f32 v135, v135
    v_rcp_f32 v136, v136
    v_rcp_f32 v137, v137
    v_rcp_f32 v138, v138
    v_rcp_f32 v139, v139
    v_rcp_f32 v140, v140
    v_rcp_f32 v141, v141
    v_rcp_f32 v142, v142
    v_rcp_f32 v143, v143
    v_pk_mul_f32 v[48:49], v[48:49], v[132:133]
    v_pk_mul_f32 v[50:51], v[50:51], v[134:135]
    v_pk_mul_f32 v[52:53], v[52:53], v[136:137]
    v_pk_mul_f32 v[54:55], v[54:55], v[138:139]
    v_pk_mul_f32 v[56:57], v[56:57], v[140:141]
    v_pk_mul_f32 v[58:59], v[58:59], v[142:143]
    v_cvt_pk_bf16_f32 v68, v48, v49
    v_cvt_pk_bf16_f32 v69, v50, v51
    v_cvt_pk_bf16_f32 v70, v52, v53
    v_cvt_pk_bf16_f32 v71, v54, v55
    buffer_store_dwordx4 v[68:71], v1, s[20:23], s50 offen sc1
    v_cvt_pk_bf16_f32 v76, v56, v57
    v_cvt_pk_bf16_f32 v77, v58, v59
    v_mov_b32 v78, v76
    v_mov_b32 v79, v77
    s_nop 1
    v_permlane16_swap_b32 v76, v78
    v_permlane16_swap_b32 v77, v79
    s_mov_b64 exec, s[72:73]
    buffer_store_dwordx4 v[76:79], v23, s[20:23], s52 offen sc1
    s_mov_b64 exec, -1
    s_barrier
    s_cmp_lg_u32 s3, 0
    s_cbranch_scc1 kb_s0_5450
    s_add_u32 s42, s46, 12288
    s_mov_b64 exec, 1
    v_mov_b32 v6, 1
    v_lshlrev_b32 v7, 8, v0
    buffer_store_dword v6, v7, s[20:23], s42 offen sc1
    s_mov_b64 exec, -1
kb_s0_5450:
    s_lshl_b32 s47, s16, 2
    s_cmp_lg_u32 s3, 0
    s_cbranch_scc1 kb_w5460_d
    s_add_u32 s42, s45, 12288
    v_lshrrev_b32 v7, 3, v0
    v_lshlrev_b32 v7, 7, v7
    v_and_b32 v6, 7, v0
    v_lshl_add_u32 v7, v6, 2, v7
    s_mov_b32 s43, 0x40000
    s_mov_b32 exec_lo, 0xff
    s_mov_b32 exec_hi, 0x0
kb_w5460:
    buffer_load_dword v6, v5, s[20:23], s42 offen sc1
    s_sub_u32 s43, s43, 1
    s_cbranch_scc1 kb_w5460_x
    s_waitcnt vmcnt(0)
    v_cmp_ne_u32 vcc, 1, v6
    s_cbranch_vccnz kb_w5460
kb_w5460_x:
    s_mov_b64 exec, -1
kb_w5460_d:
    s_barrier
p7_re:
    s_add_u32 s32, s47, 12312576
    s_add_u32 s33, s47, 12361728
    s_add_u32 s34, s47, 12410880
    buffer_load_dwordx4 v[60:63], v1, s[20:23], s32 offen offset:0 sc1
    buffer_load_dwordx4 v[64:67], v1, s[20:23], s33 offen offset:0 sc1
    buffer_load_dwordx4 v[68:71], v1, s[20:23], s34 offen offset:0 sc1
pad73:
    s_cbranch_execz wretB
    buffer_load_dwordx4 v[72:75], v1, s[20:23], s32 offen offset:1024 sc1
    buffer_load_dwordx4 v[76:79], v1, s[20:23], s33 offen offset:1024 sc1
    buffer_load_dwordx4 v[80:83], v1, s[20:23], s34 offen offset:1024 sc1
    buffer_load_dwordx4 v[84:87], v1, s[20:23], s32 offen offset:2048 sc1
    buffer_load_dwordx4 v[88:91], v1, s[20:23], s33 offen offset:2048 sc1
    buffer_load_dwordx4 v[92:95], v1, s[20:23], s34 offen offset:2048 sc1
    buffer_load_dwordx4 v[96:99], v1, s[20:23], s32 offen offset:3072 sc1
    buffer_load_dwordx4 v[100:103], v1, s[20:23], s33 offen offset:3072 sc1
    buffer_load_dwordx4 v[104:107], v1, s[20:23], s34 offen offset:3072 sc1
    s_add_u32 s32, s32, 4096
    s_add_u32 s33, s33, 4096
    s_add_u32 s34, s34, 4096
    buffer_load_dwordx4 v[108:111], v1, s[20:23], s32 offen offset:0 sc1
    buffer_load_dwordx4 v[112:115], v1, s[20:23], s33 offen offset:0 sc1
    buffer_load_dwordx4 v[116:119], v1, s[20:23], s34 offen offset:0 sc1
    buffer_load_dwordx4 v[120:123], v1, s[20:23], s32 offen offset:1024 sc1
    buffer_load_dwordx4 v[124:127], v1, s[20:23], s33 offen offset:1024 sc1
    buffer_load_dwordx4 v[128:131], v1, s[20:23], s34 offen offset:1024 sc1
    buffer_load_dwordx4 v[132:135], v1, s[20:23], s32 offen offset:2048 sc1
    buffer_load_dwordx4 v[136:139], v1, s[20:23], s33 offen offset:2048 sc1
    buffer_load_dwordx4 v[140:143], v1, s[20:23], s34 offen offset:2048 sc1
    buffer_load_dwordx4 v[144:147], v1, s[20:23], s32 offen offset:3072 sc1
    buffer_load_dwordx4 v[148:151], v1, s[20:23], s33 offen offset:3072 sc1
    buffer_load_dwordx4 v[152:155], v1, s[20:23], s34 offen offset:3072 sc1
    s_add_u32 s32, s32, 4096
    s_add_u32 s33, s33, 4096
    s_add_u32 s34, s34, 4096
    buffer_load_dwordx4 v[156:159], v1, s[20:23], s32 offen offset:0 sc1
    buffer_load_dwordx4 v[160:163], v1, s[20:23], s33 offen offset:0 sc1
    buffer_load_dwordx4 v[164:167], v1, s[20:23], s34 offen offset:0 sc1
    buffer_load_dwordx4 v[168:171], v1, s[20:23], s32 offen offset:1024 sc1
    buffer_load_dwordx4 v[172:175], v1, s[20:23], s33 offen offset:1024 sc1
    buffer_load_dwordx4 v[176:179], v1, s[20:23], s34 offen offset:1024 sc1
    buffer_load_dwordx4 v[180:183], v1, s[20:23], s32 offen offset:2048 sc1
    buffer_load_dwordx4 v[184:187], v1, s[20:23], s33 offen offset:2048 sc1
    buffer_load_dwordx4 v[188:191], v1, s[20:23], s34 offen offset:2048 sc1
    buffer_load_dwordx4 v[192:195], v1, s[20:23], s32 offen offset:3072 sc1
    buffer_load_dwordx4 v[196:199], v1, s[20:23], s33 offen offset:3072 sc1
    buffer_load_dwordx4 v[200:203], v1, s[20:23], s34 offen offset:3072 sc1
    s_waitcnt vmcnt(33)
    v_mfma_f32_16x16x32_bf16 v[24:27], a[0:3], v[60:63], 0
    v_mfma_f32_16x16x32_bf16 v[28:31], a[48:51], v[60:63], 0
    v_mfma_f32_16x16x32_bf16 v[32:35], a[96:99], v[60:63], 0
    v_mfma_f32_16x16x32_bf16 v[36:39], a[0:3], v[64:67], 0
    v_mfma_f32_16x16x32_bf16 v[40:43], a[48:51], v[64:67], 0
    v_mfma_f32_16x16x32_bf16 v[44:47], a[96:99], v[64:67], 0
    v_mfma_f32_16x16x32_bf16 v[48:51], a[0:3], v[68:71], 0
    v_mfma_f32_16x16x32_bf16 v[52:55], a[48:51], v[68:71], 0
    v_mfma_f32_16x16x32_bf16 v[56:59], a[96:99], v[68:71], 0
    v_max_u32 v8, v60, v64
    v_max_u32 v8, v8, v68
    s_waitcnt vmcnt(30)
    v_mfma_f32_16x16x32_bf16 v[24:27], a[4:7], v[72:75], v[24:27]
    v_mfma_f32_16x16x32_bf16 v[28:31], a[52:55], v[72:75], v[28:31]
    v_mfma_f32_16x16x32_bf16 v[32:35], a[100:103], v[72:75], v[32:35]
    v_mfma_f32_16x16x32_bf16 v[36:39], a[4:7], v[76:79], v[36:39]
    v_mfma_f32_16x16x32_bf16 v[40:43], a[52:55], v[76:79], v[40:43]
    v_mfma_f32_16x16x32_bf16 v[44:47], a[100:103], v[76:79], v[44:47]
    v_mfma_f32_16x16x32_bf16 v[48:51], a[4:7], v[80:83], v[48:51]
    v_mfma_f32_16x16x32_bf16 v[52:55], a[52:55], v[80:83], v[52:55]
    v_mfma_f32_16x16x32_bf16 v[56:59], a[100:103], v[80:83], v[56:59]
    v_max3_u32 v8, v8, v72, v76
    v_max_u32 v8, v8, v80
    s_waitcnt vmcnt(27)
    v_mfma_f32_16x16x32_bf16 v[24:27], a[8:11], v[84:87], v[24:27]
    v_mfma_f32_16x16x32_bf16 v[28:31], a[56:59], v[84:87], v[28:31]
    v_mfma_f32_16x16x32_bf16 v[32:35], a[104:107], v[84:87], v[32:35]
pad74:
    s_cbranch_execz wretB
    v_mfma_f32_16x16x32_bf16 v[36:39], a[8:11], v[88:91], v[36:39]
    v_mfma_f32_16x16x32_bf16 v[40:43], a[56:59], v[88:91], v[40:43]
    v_mfma_f32_16x16x32_bf16 v[44:47], a[104:107], v[88:91], v[44:47]
    v_mfma_f32_16x16x32_bf16 v[48:51], a[8:11], v[92:95], v[48:51]
    v_mfma_f32_16x16x32_bf16 v[52:55], a[56:59], v[92:95], v[52:55]
    v_mfma_f32_16x16x32_bf16 v[56:59], a[104:107], v[92:95], v[56:59]
    v_max3_u32 v8, v8, v84, v88
    v_max_u32 v8, v8, v92
    s_waitcnt vmcnt(24)
    v_mfma_f32_16x16x32_bf16 v[24:27], a[12:15], v[96:99], v[24:27]
    v_mfma_f32_16x16x32_bf16 v[28:31], a[60:63], v[96:99], v[28:31]
    v_mfma_f32_16x16x32_bf16 v[32:35], a[108:111], v[96:99], v[32:35]
    v_mfma_f32_16x16x32_bf16 v[36:39], a[12:15], v[100:103], v[36:39]
    v_mfma_f32_16x16x32_bf16 v[40:43], a[60:63], v[100:103], v[40:43]
    v_mfma_f32_16x16x32_bf16 v[44:47], a[108:111], v[100:103], v[44:47]
    v_mfma_f32_16x16x32_bf16 v[48:51], a[12:15], v[104:107], v[48:51]
    v_mfma_f32_16x16x32_bf16 v[52:55], a[60:63], v[104:107], v[52:55]
    v_mfma_f32_16x16x32_bf16 v[56:59], a[108:111], v[104:107], v[56:59]
    v_max3_u32 v8, v8, v96, v100
    v_max_u32 v8, v8, v104
    s_waitcnt vmcnt(21)
    v_mfma_f32_16x16x32_bf16 v[24:27], a[16:19], v[108:111], v[24:27]
    v_mfma_f32_16x16x32_bf16 v[28:31], a[64:67], v[108:111], v[28:31]
    v_mfma_f32_16x16x32_bf16 v[32:35], a[112:115], v[108:111], v[32:35]
    v_mfma_f32_16x16x32_bf16 v[36:39], a[16:19], v[112:115], v[36:39]
    v_mfma_f32_16x16x32_bf16 v[40:43], a[64:67], v[112:115], v[40:43]
    v_mfma_f32_16x16x32_bf16 v[44:47], a[112:115], v[112:115], v[44:47]
    v_mfma_f32_16x16x32_bf16 v[48:51], a[16:19], v[116:119], v[48:51]
    v_mfma_f32_16x16x32_bf16 v[52:55], a[64:67], v[116:119], v[52:55]
    v_mfma_f32_16x16x32_bf16 v[56:59], a[112:115], v[116:119], v[56:59]
    v_max3_u32 v8, v8, v108, v112
    v_max_u32 v8, v8, v116
    s_waitcnt vmcnt(18)
    v_mfma_f32_16x16x32_bf16 v[24:27], a[20:23], v[120:123], v[24:27]
    v_mfma_f32_16x16x32_bf16 v[28:31], a[68:71], v[120:123], v[28:31]
    v_mfma_f32_16x16x32_bf16 v[32:35], a[116:119], v[120:123], v[32:35]
    v_mfma_f32_16x16x32_bf16 v[36:39], a[20:23], v[124:127], v[36:39]
    v_mfma_f32_16x16x32_bf16 v[40:43], a[68:71], v[124:127], v[40:43]
    v_mfma_f32_16x16x32_bf16 v[44:47], a[116:119], v[124:127], v[44:47]
    v_mfma_f32_16x16x32_bf16 v[48:51], a[20:23], v[128:131], v[48:51]
    v_mfma_f32_16x16x32_bf16 v[52:55], a[68:71], v[128:131], v[52:55]
    v_mfma_f32_16x16x32_bf16 v[56:59], a[116:119], v[128:131], v[56:59]
    v_max3_u32 v8, v8, v120, v124
    v_max_u32 v8, v8, v128
    s_waitcnt vmcnt(15)
    v_mfma_f32_16x16x32_bf16 v[24:27], a[24:27], v[132:135], v[24:27]
    v_mfma_f32_16x16x32_bf16 v[28:31], a[72:75], v[132:135], v[28:31]
    v_mfma_f32_16x16x32_bf16 v[32:35], a[120:123], v[132:135], v[32:35]
    v_mfma_f32_16x16x32_bf16 v[36:39], a[24:27], v[136:139], v[36:39]
    v_mfma_f32_16x16x32_bf16 v[40:43], a[72:75], v[136:139], v[40:43]
    v_mfma_f32_16x16x32_bf16 v[44:47], a[120:123], v[136:139], v[44:47]
    v_mfma_f32_16x16x32_bf16 v[48:51], a[24:27], v[140:143], v[48:51]
    v_mfma_f32_16x16x32_bf16 v[52:55], a[72:75], v[140:143], v[52:55]
    v_mfma_f32_16x16x32_bf16 v[56:59], a[120:123], v[140:143], v[56:59]
    v_max3_u32 v8, v8, v132, v136
    v_max_u32 v8, v8, v140
    s_waitcnt vmcnt(12)
    v_mfma_f32_16x16x32_bf16 v[24:27], a[28:31], v[144:147], v[24:27]
    v_mfma_f32_16x16x32_bf16 v[28:31], a[76:79], v[144:147], v[28:31]
    v_mfma_f32_16x16x32_bf16 v[32:35], a[124:127], v[144:147], v[32:35]
    v_mfma_f32_16x16x32_bf16 v[36:39], a[28:31], v[148:151], v[36:39]
    v_mfma_f32_16x16x32_bf16 v[40:43], a[76:79], v[148:151], v[40:43]
    v_mfma_f32_16x16x32_bf16 v[44:47], a[124:127], v[148:151], v[44:47]
    v_mfma_f32_16x16x32_bf16 v[48:51], a[28:31], v[152:155], v[48:51]
    v_mfma_f32_16x16x32_bf16 v[52:55], a[76:79], v[152:155], v[52:55]
    v_mfma_f32_16x16x32_bf16 v[56:59], a[124:127], v[152:155], v[56:59]
    v_max3_u32 v8, v8, v144, v148
    v_max_u32 v8, v8, v152
    s_waitcnt vmcnt(9)
    v_mfma_f32_16x16x32_bf16 v[24:27], a[32:35], v[156:159], v[24:27]
pad75:
    s_cbranch_execz wretB
    v_mfma_f32_16x16x32_bf16 v[28:31], a[80:83], v[156:159], v[28:31]
    v_mfma_f32_16x16x32_bf16 v[32:35], a[128:131], v[156:159], v[32:35]
    v_mfma_f32_16x16x32_bf16 v[36:39], a[32:35], v[160:163], v[36:39]
    v_mfma_f32_16x16x32_bf16 v[40:43], a[80:83], v[160:163], v[40:43]
    v_mfma_f32_16x16x32_bf16 v[44:47], a[128:131], v[160:163], v[44:47]
    v_mfma_f32_16x16x32_bf16 v[48:51], a[32:35], v[164:167], v[48:51]
    v_mfma_f32_16x16x32_bf16 v[52:55], a[80:83], v[164:167], v[52:55]
    v_mfma_f32_16x16x32_bf16 v[56:59], a[128:131], v[164:167], v[56:59]
    v_max3_u32 v8, v8, v156, v160
    v_max_u32 v8, v8, v164
    s_waitcnt vmcnt(6)
    v_mfma_f32_16x16x32_bf16 v[24:27], a[36:39], v[168:171], v[24:27]
    v_mfma_f32_16x16x32_bf16 v[28:31], a[84:87], v[168:171], v[28:31]
    v_mfma_f32_16x16x32_bf16 v[32:35], a[132:135], v[168:171], v[32:35]
    v_mfma_f32_16x16x32_bf16 v[36:39], a[36:39], v[172:175], v[36:39]
    v_mfma_f32_16x16x32_bf16 v[40:43], a[84:87], v[172:175], v[40:43]
    v_mfma_f32_16x16x32_bf16 v[44:47], a[132:135], v[172:175], v[44:47]
    v_mfma_f32_16x16x32_bf16 v[48:51], a[36:39], v[176:179], v[48:51]
    v_mfma_f32_16x16x32_bf16 v[52:55], a[84:87], v[176:179], v[52:55]
    v_mfma_f32_16x16x32_bf16 v[56:59], a[132:135], v[176:179], v[56:59]
    v_max3_u32 v8, v8, v168, v172
    v_max_u32 v8, v8, v176
    s_waitcnt vmcnt(3)
    v_mfma_f32_16x16x32_bf16 v[24:27], a[40:43], v[180:183], v[24:27]
    v_mfma_f32_16x16x32_bf16 v[28:31], a[88:91], v[180:183], v[28:31]
    v_mfma_f32_16x16x32_bf16 v[32:35], a[136:139], v[180:183], v[32:35]
    v_mfma_f32_16x16x32_bf16 v[36:39], a[40:43], v[184:187], v[36:39]
    v_mfma_f32_16x16x32_bf16 v[40:43], a[88:91], v[184:187], v[40:43]
    v_mfma_f32_16x16x32_bf16 v[44:47], a[136:139], v[184:187], v[44:47]
    v_mfma_f32_16x16x32_bf16 v[48:51], a[40:43], v[188:191], v[48:51]
    v_mfma_f32_16x16x32_bf16 v[52:55], a[88:91], v[188:191], v[52:55]
    v_mfma_f32_16x16x32_bf16 v[56:59], a[136:139], v[188:191], v[56:59]
    v_max3_u32 v8, v8, v180, v184
    v_max_u32 v8, v8, v188
    s_waitcnt vmcnt(0)
    v_mfma_f32_16x16x32_bf16 v[24:27], a[44:47], v[192:195], v[24:27]
    v_mfma_f32_16x16x32_bf16 v[28:31], a[92:95], v[192:195], v[28:31]
    v_mfma_f32_16x16x32_bf16 v[32:35], a[140:143], v[192:195], v[32:35]
    v_mfma_f32_16x16x32_bf16 v[36:39], a[44:47], v[196:199], v[36:39]
    v_mfma_f32_16x16x32_bf16 v[40:43], a[92:95], v[196:199], v[40:43]
    v_mfma_f32_16x16x32_bf16 v[44:47], a[140:143], v[196:199], v[44:47]
    v_mfma_f32_16x16x32_bf16 v[48:51], a[44:47], v[200:203], v[48:51]
    v_mfma_f32_16x16x32_bf16 v[52:55], a[92:95], v[200:203], v[52:55]
    v_mfma_f32_16x16x32_bf16 v[56:59], a[140:143], v[200:203], v[56:59]
    v_max3_u32 v8, v8, v192, v196
    v_max_u32 v8, v8, v200
    v_cmp_eq_u32 vcc, -1, v8
    s_cbranch_vccz p7_re_ok
    s_sub_u32 s40, s40, 1
    s_cbranch_scc0 p7_re
    s_mov_b32 s40, 0
p7_re_ok:
    s_mul_i32 s42, s3, 9216
    s_add_u32 s42, s42, 36864
    v_add_u32 v6, s42, v1
    s_mul_i32 s42, s3, 3072
    s_add_u32 s42, s42, 36864
    v_add_u32 v7, s42, v1
    s_nop 2
    ds_write_b128 v6, v[24:27] offset:0
    ds_write_b128 v6, v[28:31] offset:1024
    ds_write_b128 v6, v[32:35] offset:2048
    ds_write_b128 v6, v[36:39] offset:3072
    ds_write_b128 v6, v[40:43] offset:4096
    ds_write_b128 v6, v[44:47] offset:5120
    ds_write_b128 v6, v[48:51] offset:6144
    ds_write_b128 v6, v[52:55] offset:7168
    ds_write_b128 v6, v[56:59] offset:8192
    s_waitcnt lgkmcnt(0)
    s_barrier
    s_cmp_eq_u32 s3, 3
    s_cbranch_scc1 p7_fin
    ds_read_b128 v[60:63], v7 offset:0
pad76:
    s_cbranch_execz wretB
    ds_read_b128 v[64:67], v7 offset:1024
    ds_read_b128 v[68:71], v7 offset:2048
    ds_read_b128 v[72:75], v7 offset:9216
    ds_read_b128 v[76:79], v7 offset:10240
    ds_read_b128 v[80:83], v7 offset:11264
    ds_read_b128 v[84:87], v7 offset:18432
    ds_read_b128 v[88:91], v7 offset:19456
    ds_read_b128 v[92:95], v7 offset:20480
    ds_read_b128 v[96:99], v7 offset:27648
    ds_read_b128 v[100:103], v7 offset:28672
    ds_read_b128 v[104:107], v7 offset:29696
    v_lshlrev_b32 v24, 16, v16
    v_and_b32 v25, 0xffff0000, v16
    v_lshlrev_b32 v26, 16, v17
    v_and_b32 v27, 0xffff0000, v17
    v_lshlrev_b32 v28, 16, v18
    v_and_b32 v29, 0xffff0000, v18
    v_lshlrev_b32 v30, 16, v19
    v_and_b32 v31, 0xffff0000, v19
    v_lshlrev_b32 v32, 16, v20
    v_and_b32 v33, 0xffff0000, v20
    v_lshlrev_b32 v34, 16, v21
    v_and_b32 v35, 0xffff0000, v21
    s_waitcnt lgkmcnt(9)
    v_pk_add_f32 v[24:25], v[24:25], v[60:61]
    v_pk_add_f32 v[26:27], v[26:27], v[62:63]
    v_pk_add_f32 v[28:29], v[28:29], v[64:65]
    v_pk_add_f32 v[30:31], v[30:31], v[66:67]
    v_pk_add_f32 v[32:33], v[32:33], v[68:69]
    v_pk_add_f32 v[34:35], v[34:35], v[70:71]
    s_waitcnt lgkmcnt(6)
    v_pk_add_f32 v[24:25], v[24:25], v[72:73]
    v_pk_add_f32 v[26:27], v[26:27], v[74:75]
    v_pk_add_f32 v[28:29], v[28:29], v[76:77]
    v_pk_add_f32 v[30:31], v[30:31], v[78:79]
    v_pk_add_f32 v[32:33], v[32:33], v[80:81]
    v_pk_add_f32 v[34:35], v[34:35], v[82:83]
    s_waitcnt lgkmcnt(3)
    v_pk_add_f32 v[24:25], v[24:25], v[84:85]
    v_pk_add_f32 v[26:27], v[26:27], v[86:87]
    v_pk_add_f32 v[28:29], v[28:29], v[88:89]
    v_pk_add_f32 v[30:31], v[30:31], v[90:91]
    v_pk_add_f32 v[32:33], v[32:33], v[92:93]
    v_pk_add_f32 v[34:35], v[34:35], v[94:95]
    s_waitcnt lgkmcnt(0)
    v_pk_add_f32 v[24:25], v[24:25], v[96:97]
    v_pk_add_f32 v[26:27], v[26:27], v[98:99]
    v_pk_add_f32 v[28:29], v[28:29], v[100:101]
    v_pk_add_f32 v[30:31], v[30:31], v[102:103]
    v_pk_add_f32 v[32:33], v[32:33], v[104:105]
    v_pk_add_f32 v[34:35], v[34:35], v[106:107]
    v_cvt_pk_bf16_f32 v16, v24, v25
    v_cvt_pk_bf16_f32 v17, v26, v27
    v_cvt_pk_bf16_f32 v18, v28, v29
    v_cvt_pk_bf16_f32 v19, v30, v31
    v_cvt_pk_bf16_f32 v20, v32, v33
    v_cvt_pk_bf16_f32 v21, v34, v35
    buffer_store_dwordx2 v[16:17], v4, s[28:31], s74 offen
    buffer_store_dwordx2 v[18:19], v4, s[28:31], s75 offen
    buffer_store_dwordx2 v[20:21], v4, s[28:31], s76 offen
p7_fin:
kb_end:
    s_endpgm
.section .rodata,"a"
.p2align 6
.amdhsa_kernel km_kernel
  .amdhsa_next_free_vgpr 512
  .amdhsa_next_free_sgpr 102
  .amdhsa_accum_offset 256
  .amdhsa_group_segment_fixed_size 0
  .amdhsa_kernarg_size 80
  .amdhsa_user_sgpr_count 2
  .amdhsa_user_sgpr_kernarg_segment_ptr 1
  .amdhsa_system_sgpr_workgroup_id_x 1
.end_amdhsa_kernel
```
